```python
import torch

def _softmax(x, axis=-1):
    return torch.softmax(x, dim=axis)
def _gelu(x):
    return torch.nn.functional.gelu(x, approximate="tanh")
def _silu(x):
    return torch.nn.functional.silu(x)
def _sigmoid(x):
    return torch.sigmoid(x)
def _layernorm(x, axis=-1, eps=1e-5):
    m = x.mean(dim=axis, keepdim=True)
    v = x.var(dim=axis, keepdim=True, unbiased=False)
    return (x - m) / torch.sqrt(v + eps)
def _scatter_add(tgt, idx, src, axis=0):
    return tgt.clone().index_add_(axis, idx, src)
def _segment_sum(src, seg, n):
    out = torch.zeros((n,) + src.shape[1:], dtype=src.dtype)
    return out.index_add_(0, seg, src)
def _pad(x, pw):
    flat = tuple(v for pair in reversed(pw) for v in pair)
    return torch.nn.functional.pad(x, flat)

kernel_name = 'parallel_sum__mha_block_cached__geglu_ffn__decode'

def setup_inputs():

    _w = (lambda a: (lambda t: t.to(torch.bfloat16) if t.is_floating_point() else t)(torch.as_tensor(a)))
    def _A_setup():
        B, Sq, D = 1, 1, 1024
        H, Sk, Dh = 32, 32768, 128
        return {
            "x": _w((lambda *s: torch.randn(*s, dtype=torch.bfloat16) * 0.05)(B, Sq, D)),
            "k_cache": _w((lambda *s: torch.randn(*s, dtype=torch.bfloat16) * 3.2)(B, H, Sk, Dh)),
            "v_cache": _w((lambda *s: torch.randn(*s, dtype=torch.bfloat16) * 1.6)(B, H, Sk, Dh)),
            "wq": _w((lambda *s: torch.randn(*s, dtype=torch.bfloat16) * 3.2)(D, H * Dh) * (D ** -0.5)),
            "wo": _w((lambda *s: torch.randn(*s, dtype=torch.bfloat16) * 1.6)(H * Dh, D) * ((H * Dh) ** -0.5)),
        }
    _A_in = _A_setup()

    def _B_setup():
        B, S, D, F = 1, 1, 1024, 3584
        return {
            "x": _w((lambda *s: torch.randn(*s, dtype=torch.bfloat16) * 0.05)(B, S, D)),
            "w_gate": _w((lambda *s: torch.randn(*s, dtype=torch.bfloat16) * 0.05)(D, F)),
            "w_up": _w((lambda *s: torch.randn(*s, dtype=torch.bfloat16) * 0.05)(D, F)),
            "w_down": _w((lambda *s: torch.randn(*s, dtype=torch.bfloat16) * 0.05)(F, D)),
        }
    _B_in = _B_setup()

    return {
        "A_x": _A_in["x"],
        "A_k_cache": _A_in["k_cache"],
        "A_v_cache": _A_in["v_cache"],
        "A_wq": _A_in["wq"],
        "A_wo": _A_in["wo"],
        "B_x": _B_in["x"],
        "B_w_gate": _B_in["w_gate"],
        "B_w_up": _B_in["w_up"],
        "B_w_down": _B_in["w_down"],
    }

def reference(A_x, A_k_cache, A_v_cache, A_wq, A_wo, B_x, B_w_gate, B_w_up, B_w_down):
    def _A_ref(x, k_cache, v_cache, wq, wo):
        B, Sq, D = x.shape
        H, Dh = 32, 128
        q = (lambda x, *d: x.permute(*d))((x @ wq).reshape(B, Sq, H, Dh), 0, 2, 1, 3)
        scores = torch.einsum("bhqd,bhkd->bhqk", q, k_cache) * (Dh ** -0.5)
        p = _softmax(scores, axis=-1)
        o = torch.einsum("bhqk,bhkd->bhqd", p, v_cache)
        return (lambda x, *d: x.permute(*d))(o, 0, 2, 1, 3).reshape(B, Sq, H * Dh) @ wo

    def _B_ref(x, w_gate, w_up, w_down):
        return (_gelu(x @ w_gate) * (x @ w_up)) @ w_down

    x = A_x
    xn = _layernorm(x, axis=-1)
    return x + _A_ref(xn, A_k_cache, A_v_cache, A_wq, A_wo) + _B_ref(xn, B_w_gate, B_w_up, B_w_down)
```

```asm
; @launch grid=(256,1,1) block=(576,1,1) lds=54544
.amdgcn_target "amdgcn-amd-amdhsa--gfx950"
.text
.globl parallel_sum__mha_block_cached__geglu_ffn__decode_kernel
.p2align 8
.type parallel_sum__mha_block_cached__geglu_ffn__decode_kernel,@function
parallel_sum__mha_block_cached__geglu_ffn__decode_kernel:
    s_cmp_ge_u32 s2, 256
    s_cbranch_scc1 L_end
    s_load_dwordx16 s[4:19], s[0:1], 0
    s_load_dwordx8 s[20:27], s[0:1], 64
    v_lshrrev_b32 v1, 6, v0
    s_lshr_b32 s29, s2, 3
    v_readfirstlane_b32 s28, v1
    s_and_b32 s30, s2, 7
    s_mul_i32 s3, s30, 5
    s_add_u32 s3, s3, s29
    s_and_b32 s3, s3, 31
    v_and_b32 v2, 15, v0
    v_bfe_u32 v3, v0, 4, 2
    v_and_b32 v1, 63, v0
    s_cmp_eq_u32 s28, 8
    s_cbranch_scc1 L_service
    v_lshlrev_b32 v6, 5, v1
    s_lshl_b32 s31, s30, 7
    s_lshl_b32 s32, s28, 4
    s_add_u32 s31, s31, s32
    v_lshl_add_u32 v10, v3, 2, s31
    v_lshlrev_b32 v7, 1, v10
    s_lshl_b32 s32, s29, 8
    v_lshl_add_u32 v11, v2, 4, s32
    v_lshl_add_u32 v8, v10, 13, v11
    s_movk_i32 s33, 7168
    s_lshl_b32 s32, s3, 8
    v_lshl_add_u32 v11, v2, 4, s32
    s_cmp_lt_u32 s3, 28
    s_cselect_b32 s33, s33, 0
    s_cselect_b32 s34, -1, 0
    v_mul_u32_u24 v9, s33, v10
    v_and_b32 v11, s34, v11
    v_add_u32 v9, v9, v11
    v_bfe_u32 v5, v0, 4, 2
    v_lshlrev_b32 v5, 15, v5
    v_lshl_add_u32 v5, v2, 4, v5
    v_bfe_u32 v4, v0, 2, 2
    v_lshlrev_b32 v4, 12, v4
    v_and_b32 v11, 3, v0
    v_lshl_add_u32 v4, v3, 6, v4
    v_lshl_add_u32 v4, v11, 4, v4
    s_lshl_b32 s37, s30, 3
    s_add_u32 s37, s37, s28
    s_lshl_b32 s31, s29, 23
    s_waitcnt lgkmcnt(0)
    global_load_dwordx4 v[44:47], v6, s[4:5]
    global_load_dwordx4 v[48:51], v6, s[4:5] offset:16
    global_load_dwordx2 v[164:165], v7, s[4:5]
    global_load_dwordx4 v[116:119], v8, s[10:11] nt
    v_add_u32 v8, 0x2000, v8
    global_load_dwordx4 v[120:123], v8, s[10:11] nt
    v_add_u32 v8, 0x2000, v8
    global_load_dwordx4 v[124:127], v8, s[10:11] nt
    v_add_u32 v8, 0x2000, v8
    global_load_dwordx4 v[128:131], v8, s[10:11] nt
    s_add_u32 s40, s6, s31
    s_addc_u32 s41, s7, 0
    s_mov_b32 s42, 0x800000
    s_mov_b32 s43, 0x20000
    s_add_u32 s44, s8, s31
    s_addc_u32 s45, s9, 0
    s_mov_b32 s46, 0x800000
    s_mov_b32 s47, 0x20000
    v_and_b32 v10, 1, v2
    v_lshlrev_b32 v10, 4, v10
    v_mov_b32 v11, 0xffff
    v_lshlrev_b32 v11, v10, v11
    v_bfe_u32 v10, v2, 1, 2
    v_cmp_eq_u32 vcc, 0, v10
    s_nop 1
    v_cndmask_b32 v12, 0, v11, vcc
    v_cmp_eq_u32 vcc, 1, v10
    s_nop 1
    v_cndmask_b32 v13, 0, v11, vcc
    v_cmp_eq_u32 vcc, 2, v10
    s_nop 1
    v_cndmask_b32 v14, 0, v11, vcc
    v_cmp_eq_u32 vcc, 3, v10
    s_nop 1
    v_cndmask_b32 v15, 0, v11, vcc
    s_add_u32 s48, s37, 0
    s_lshl_b32 s48, s48, 1
    s_lshr_b32 s31, s48, 3
    s_and_b32 s31, s31, 0x70
    s_xor_b32 s32, s48, s31
    s_bfe_u32 s31, s32, 0x40000
    s_lshl_b32 s52, s31, 8
    s_bfe_u32 s31, s32, 0x10004
    s_lshl_b32 s31, s31, 21
    s_or_b32 s52, s52, s31
    s_bfe_u32 s31, s32, 0x10005
    s_lshl_b32 s31, s31, 14
    s_or_b32 s52, s52, s31
    s_bfe_u32 s31, s32, 0x40006
    s_lshl_b32 s31, s31, 17
    s_or_b32 s52, s52, s31
    s_bfe_u32 s31, s32, 0x1000a
    s_lshl_b32 s31, s31, 22
    s_or_b32 s52, s52, s31
    s_add_u32 s49, s37, 64
    s_lshl_b32 s49, s49, 1
    s_lshr_b32 s31, s49, 3
    s_and_b32 s31, s31, 0x70
    s_xor_b32 s32, s49, s31
    s_bfe_u32 s31, s32, 0x40000
    s_lshl_b32 s53, s31, 8
    s_bfe_u32 s31, s32, 0x10004
    s_lshl_b32 s31, s31, 21
    s_or_b32 s53, s53, s31
    s_bfe_u32 s31, s32, 0x10005
    s_lshl_b32 s31, s31, 14
    s_or_b32 s53, s53, s31
    s_bfe_u32 s31, s32, 0x40006
    s_lshl_b32 s31, s31, 17
    s_or_b32 s53, s53, s31
    s_bfe_u32 s31, s32, 0x1000a
    s_lshl_b32 s31, s31, 22
    s_or_b32 s53, s53, s31
    s_waitcnt vmcnt(4)
    v_mov_b32 v40, v9
    s_mov_b32 exec_lo, s34
    s_mov_b32 exec_hi, s34
    global_load_dwordx4 v[132:135], v40, s[16:17] nt
    v_add_u32 v40, s33, v40
    global_load_dwordx4 v[136:139], v40, s[16:17] nt
    v_add_u32 v40, s33, v40
    global_load_dwordx4 v[140:143], v40, s[16:17] nt
    v_add_u32 v40, s33, v40
    global_load_dwordx4 v[144:147], v40, s[16:17] nt
    s_mov_b64 exec, -1
    v_lshlrev_b32 v16, 16, v44
    v_and_b32 v17, 0xffff0000, v44
    v_lshlrev_b32 v18, 16, v45
    v_and_b32 v19, 0xffff0000, v45
    v_lshlrev_b32 v20, 16, v46
    v_and_b32 v21, 0xffff0000, v46
    v_lshlrev_b32 v22, 16, v47
    v_and_b32 v23, 0xffff0000, v47
    v_lshlrev_b32 v24, 16, v48
    v_and_b32 v25, 0xffff0000, v48
    v_lshlrev_b32 v26, 16, v49
    v_and_b32 v27, 0xffff0000, v49
    v_lshlrev_b32 v28, 16, v50
    v_and_b32 v29, 0xffff0000, v50
    v_lshlrev_b32 v30, 16, v51
    v_and_b32 v31, 0xffff0000, v51
    v_add_f32 v6, v16, v17
    v_add_f32 v7, v18, v19
    v_add_f32 v6, v6, v20
    v_add_f32 v7, v7, v21
    v_add_f32 v6, v6, v22
    v_add_f32 v7, v7, v23
    v_add_f32 v6, v6, v24
    v_add_f32 v7, v7, v25
    v_add_f32 v6, v6, v26
    v_add_f32 v7, v7, v27
    v_add_f32 v6, v6, v28
    v_add_f32 v7, v7, v29
    v_add_f32 v6, v6, v30
    v_add_f32 v7, v7, v31
    v_add_f32 v6, v6, v7
    s_nop 1
    v_add_f32_dpp v6, v6, v6 row_ror:8 row_mask:0xf bank_mask:0xf
    s_nop 1
    v_add_f32_dpp v6, v6, v6 row_ror:4 row_mask:0xf bank_mask:0xf
    s_nop 1
    v_add_f32_dpp v6, v6, v6 row_ror:2 row_mask:0xf bank_mask:0xf
    s_nop 1
    v_add_f32_dpp v6, v6, v6 row_ror:1 row_mask:0xf bank_mask:0xf
    v_mov_b32 v7, v6
    s_nop 1
    v_permlane16_swap_b32 v6, v7
    v_add_f32 v6, v6, v7
    v_mov_b32 v7, v6
    s_nop 1
    v_permlane32_swap_b32 v6, v7
    v_add_f32 v6, v6, v7
    v_mul_f32 v6, 0x3a800000, v6
    v_sub_f32 v16, v16, v6
    v_sub_f32 v17, v17, v6
    v_sub_f32 v18, v18, v6
    v_sub_f32 v19, v19, v6
    v_sub_f32 v20, v20, v6
    v_sub_f32 v21, v21, v6
    v_sub_f32 v22, v22, v6
    v_sub_f32 v23, v23, v6
    v_sub_f32 v24, v24, v6
    v_sub_f32 v25, v25, v6
    v_sub_f32 v26, v26, v6
    v_sub_f32 v27, v27, v6
    v_sub_f32 v28, v28, v6
    v_sub_f32 v29, v29, v6
    v_sub_f32 v30, v30, v6
    v_sub_f32 v31, v31, v6
    v_mul_f32 v8, v16, v16
    v_mul_f32 v7, v17, v17
    v_fmac_f32 v8, v18, v18
    v_fmac_f32 v7, v19, v19
    v_fmac_f32 v8, v20, v20
    v_fmac_f32 v7, v21, v21
    v_fmac_f32 v8, v22, v22
    v_fmac_f32 v7, v23, v23
    v_fmac_f32 v8, v24, v24
    v_fmac_f32 v7, v25, v25
    v_fmac_f32 v8, v26, v26
    v_fmac_f32 v7, v27, v27
    v_fmac_f32 v8, v28, v28
    v_fmac_f32 v7, v29, v29
    v_fmac_f32 v8, v30, v30
    v_fmac_f32 v7, v31, v31
    v_add_f32 v8, v8, v7
    s_nop 1
    v_add_f32_dpp v8, v8, v8 row_ror:8 row_mask:0xf bank_mask:0xf
    s_nop 1
    v_add_f32_dpp v8, v8, v8 row_ror:4 row_mask:0xf bank_mask:0xf
    s_nop 1
    v_add_f32_dpp v8, v8, v8 row_ror:2 row_mask:0xf bank_mask:0xf
    s_nop 1
    v_add_f32_dpp v8, v8, v8 row_ror:1 row_mask:0xf bank_mask:0xf
    v_mov_b32 v7, v8
    s_nop 1
    v_permlane16_swap_b32 v8, v7
    v_add_f32 v8, v8, v7
    v_mov_b32 v7, v8
    s_nop 1
    v_permlane32_swap_b32 v8, v7
    v_add_f32 v8, v8, v7
    v_mul_f32 v8, 0x3a800000, v8
    v_cvt_pk_bf16_f32 v6, v6, v6
    v_lshlrev_b32 v6, 16, v6
    v_cvt_pk_bf16_f32 v8, v8, v8
    v_lshlrev_b32 v8, 16, v8
    v_add_f32 v8, 0x3727c5ac, v8
    v_cvt_pk_bf16_f32 v8, v8, v8
    v_lshlrev_b32 v8, 16, v8
    v_sqrt_f32 v8, v8
    s_nop 0
    v_cvt_pk_bf16_f32 v8, v8, v8
    v_lshlrev_b32 v8, 16, v8
    v_rcp_f32 v8, v8
    v_lshlrev_b32 v44, 16, v164
    v_and_b32 v45, 0xffff0000, v164
    v_lshlrev_b32 v46, 16, v165
    v_and_b32 v47, 0xffff0000, v165
    v_sub_f32 v44, v44, v6
    v_sub_f32 v45, v45, v6
    v_sub_f32 v46, v46, v6
    v_sub_f32 v47, v47, v6
    v_cvt_pk_bf16_f32 v44, v44, v44
    v_cvt_pk_bf16_f32 v45, v45, v45
    v_cvt_pk_bf16_f32 v46, v46, v46
    v_cvt_pk_bf16_f32 v47, v47, v47
    v_lshlrev_b32 v44, 16, v44
    v_lshlrev_b32 v45, 16, v45
    v_lshlrev_b32 v46, 16, v46
    v_lshlrev_b32 v47, 16, v47
    v_mul_f32 v44, v44, v8
    v_mul_f32 v45, v45, v8
    v_mul_f32 v46, v46, v8
    v_mul_f32 v47, v47, v8
    v_cvt_pk_bf16_f32 v44, v44, v44
    v_cvt_pk_bf16_f32 v45, v45, v45
    v_cvt_pk_bf16_f32 v46, v46, v46
    v_cvt_pk_bf16_f32 v47, v47, v47
    v_and_b32 v16, v44, v12
    v_and_b32 v17, v44, v13
    v_and_b32 v18, v44, v14
    v_and_b32 v19, v44, v15
    v_and_b32 v20, v45, v12
    v_and_b32 v21, v45, v13
    v_and_b32 v22, v45, v14
    v_and_b32 v23, v45, v15
    v_and_b32 v24, v46, v12
    v_and_b32 v25, v46, v13
    v_and_b32 v26, v46, v14
    v_and_b32 v27, v46, v15
    v_and_b32 v28, v47, v12
    v_and_b32 v29, v47, v13
    v_and_b32 v30, v47, v14
    v_and_b32 v31, v47, v15
    v_and_b32 v10, 1, v3
    v_lshlrev_b32 v10, 4, v10
    v_lshl_add_u32 v10, v2, 5, v10
    s_mul_i32 s31, s28, 1536
    v_add_u32 v11, s31, v10
    s_waitcnt vmcnt(4)
    v_mov_b32 v40, v9
    s_mov_b32 exec_lo, s34
    s_mov_b32 exec_hi, s34
    global_load_dwordx4 v[148:151], v40, s[18:19] nt
    v_add_u32 v40, s33, v40
    global_load_dwordx4 v[152:155], v40, s[18:19] nt
    v_add_u32 v40, s33, v40
    global_load_dwordx4 v[156:159], v40, s[18:19] nt
    v_add_u32 v40, s33, v40
    global_load_dwordx4 v[160:163], v40, s[18:19] nt
    s_mov_b64 exec, -1
    v_mfma_f32_16x16x32_bf16 v[40:43], v[16:19], v[116:119], 0
    v_mfma_f32_16x16x32_bf16 v[40:43], v[20:23], v[120:123], v[40:43]
    v_mfma_f32_16x16x32_bf16 v[40:43], v[24:27], v[124:127], v[40:43]
    v_mfma_f32_16x16x32_bf16 v[40:43], v[28:31], v[128:131], v[40:43]
    s_nop 7
    ds_write_b128 v11, v[40:43] offset:0
    s_waitcnt lgkmcnt(0)
    s_barrier
    s_waitcnt vmcnt(4)
    buffer_load_dwordx4 v[52:55], v4, s[40:43], s52 offen offset:0 nt
    s_add_u32 s56, s52, 0x8000
    buffer_load_dwordx4 v[56:59], v4, s[40:43], s56 offen offset:0 nt
    s_add_u32 s56, s52, 0x10000
    buffer_load_dwordx4 v[60:63], v4, s[40:43], s56 offen offset:0 nt
    s_add_u32 s56, s52, 0x18000
    buffer_load_dwordx4 v[64:67], v4, s[40:43], s56 offen offset:0 nt
    s_waitcnt vmcnt(4)
    s_or_b32 s58, s52, 0x100
    buffer_load_dwordx4 v[68:71], v4, s[40:43], s58 offen offset:0 nt
    s_add_u32 s56, s58, 0x8000
    buffer_load_dwordx4 v[72:75], v4, s[40:43], s56 offen offset:0 nt
    s_add_u32 s56, s58, 0x10000
    buffer_load_dwordx4 v[76:79], v4, s[40:43], s56 offen offset:0 nt
    s_add_u32 s56, s58, 0x18000
    buffer_load_dwordx4 v[80:83], v4, s[40:43], s56 offen offset:0 nt
    v_mfma_f32_16x16x32_bf16 v[32:35], v[16:19], v[132:135], 0
    v_mfma_f32_16x16x32_bf16 v[36:39], v[16:19], v[148:151], 0
    v_mfma_f32_16x16x32_bf16 v[32:35], v[20:23], v[136:139], v[32:35]
    v_mfma_f32_16x16x32_bf16 v[36:39], v[20:23], v[152:155], v[36:39]
    v_mfma_f32_16x16x32_bf16 v[32:35], v[24:27], v[140:143], v[32:35]
    v_mfma_f32_16x16x32_bf16 v[36:39], v[24:27], v[156:159], v[36:39]
    v_mfma_f32_16x16x32_bf16 v[32:35], v[28:31], v[144:147], v[32:35]
    v_mfma_f32_16x16x32_bf16 v[36:39], v[28:31], v[160:163], v[36:39]
    s_nop 6
    ds_write_b128 v11, v[32:35] offset:512
    ds_write_b128 v11, v[36:39] offset:1024
    s_lshl_b32 s31, s29, 7
    s_lshl_b32 s32, s28, 4
    s_add_u32 s31, s31, s32
    v_lshl_add_u32 v164, v3, 2, s31
    v_lshlrev_b32 v164, 11, v164
    s_lshl_b32 s31, s30, 8
    v_lshl_add_u32 v164, v2, 4, v164
    v_add_u32 v164, s31, v164
    s_sub_u32 s31, s3, s29
    s_lshl_b32 s31, s31, 18
    v_add_u32 v165, s31, v164
    v_and_b32 v165, s34, v165
    v_add_u32 v164, 0x1000, v164
    v_add_u32 v165, 0x1000, v165
    v_and_b32 v8, 3, v2
    v_lshlrev_b32 v8, 4, v8
    v_lshl_add_u32 v8, v3, 6, v8
    v_lshrrev_b32 v9, 2, v2
    s_waitcnt lgkmcnt(0)
    v_mov_b32 v32, 0
    v_mov_b32 v36, 0
    v_mov_b32 v33, 0
    v_mov_b32 v37, 0
    v_mov_b32 v34, 0
    v_mov_b32 v38, 0
    v_mov_b32 v35, 0
    v_mov_b32 v39, 0
    v_mov_b32 v6, 0xff7fffff
    v_mov_b32 v7, 0
    s_sub_u32 s31, s37, 1728
    s_and_b32 s31, s31, 0xffff
    v_mov_b32 v148, s31
    s_lshl_b32 s31, s29, 8
    s_add_u32 s31, s31, 0x400000
    v_mov_b32 v149, s31
    v_mov_b32 v150, 1
    v_add_u32 v154, 0x2000, v149
    s_sub_u32 s31, s37, 704
    v_mov_b32 v148, s31
    s_lshl_b32 s31, s28, 12
    v_and_b32 v151, 60, v1
    v_add_u32 v151, s31, v151
    v_mov_b32 v152, v151
    v_mov_b32 v153, 0
    v_writelane_b32 v153, s52, 0
    v_writelane_b32 v153, s53, 1
    s_mov_b32 s57, 0
    s_mov_b32 s59, 2
    s_mov_b32 s60, 0
    s_mov_b32 s62, 0
    s_mov_b32 s50, 0
    s_mov_b32 s51, 0
    s_waitcnt vmcnt(4)
    buffer_load_dwordx4 v[84:87], v4, s[40:43], s53 offen offset:0 nt
    s_add_u32 s56, s53, 0x8000
    buffer_load_dwordx4 v[88:91], v4, s[40:43], s56 offen offset:0 nt
    s_add_u32 s56, s53, 0x10000
    buffer_load_dwordx4 v[92:95], v4, s[40:43], s56 offen offset:0 nt
    s_add_u32 s56, s53, 0x18000
    buffer_load_dwordx4 v[96:99], v4, s[40:43], s56 offen offset:0 nt
    s_or_b32 s58, s53, 0x100
    s_waitcnt vmcnt(4)
    buffer_load_dwordx4 v[100:103], v4, s[40:43], s58 offen offset:0 nt
    s_add_u32 s56, s58, 0x8000
    buffer_load_dwordx4 v[104:107], v4, s[40:43], s56 offen offset:0 nt
    s_add_u32 s56, s58, 0x10000
    buffer_load_dwordx4 v[108:111], v4, s[40:43], s56 offen offset:0 nt
    s_add_u32 s56, s58, 0x18000
    buffer_load_dwordx4 v[112:115], v4, s[40:43], s56 offen offset:0 nt
    s_barrier
    ds_read_b128 v[44:47], v8 offset:12288
    s_waitcnt lgkmcnt(0)
    v_cmp_eq_u32 vcc, 0, v9
    s_nop 1
    v_cndmask_b32 v16, 0, v44, vcc
    v_cndmask_b32 v17, 0, v45, vcc
    v_cndmask_b32 v18, 0, v46, vcc
    v_cndmask_b32 v19, 0, v47, vcc
    v_cmp_eq_u32 vcc, 1, v9
    s_nop 1
    v_cndmask_b32 v20, 0, v44, vcc
    v_cndmask_b32 v21, 0, v45, vcc
    v_cndmask_b32 v22, 0, v46, vcc
    v_cndmask_b32 v23, 0, v47, vcc
    v_cmp_eq_u32 vcc, 2, v9
    s_nop 1
    v_cndmask_b32 v24, 0, v44, vcc
    v_cndmask_b32 v25, 0, v45, vcc
    v_cndmask_b32 v26, 0, v46, vcc
    v_cndmask_b32 v27, 0, v47, vcc
    v_cmp_eq_u32 vcc, 3, v9
    s_nop 1
    v_cndmask_b32 v28, 0, v44, vcc
    v_cndmask_b32 v29, 0, v45, vcc
    v_cndmask_b32 v30, 0, v46, vcc
    v_cndmask_b32 v31, 0, v47, vcc
L_gt0:
    s_cmp_lg_u32 s50, 0
    s_cbranch_scc1 L_gv0
    v_mfma_f32_16x16x32_bf16 v[40:43], v[16:19], v[52:55], 0
    v_mfma_f32_16x16x32_bf16 v[40:43], v[20:23], v[56:59], v[40:43]
    v_mfma_f32_16x16x32_bf16 v[40:43], v[24:27], v[60:63], v[40:43]
    v_mfma_f32_16x16x32_bf16 v[40:43], v[28:31], v[64:67], v[40:43]
    s_nop 7
    v_mov_b32_dpp v8, v40 quad_perm:[0,0,0,0] row_mask:0xf bank_mask:0xf
    v_mov_b32_dpp v9, v42 quad_perm:[2,2,2,2] row_mask:0xf bank_mask:0xf
    s_nop 0
    v_add_f32_dpp v8, v41, v8 quad_perm:[1,1,1,1] row_mask:0xf bank_mask:0xf
    v_add_f32_dpp v9, v43, v9 quad_perm:[3,3,3,3] row_mask:0xf bank_mask:0xf
    v_add_f32 v8, v8, v9
    v_cvt_pk_bf16_f32 v8, v8, v8
    v_lshlrev_b32 v8, 16, v8
    v_mul_f32 v8, 0x3db504f3, v8
    v_cvt_pk_bf16_f32 v8, v8, v8
    v_lshlrev_b32 v8, 16, v8
    ds_write_b32 v151, v8 offset:21760
    s_cmp_lg_u32 s62, 0
    s_cbranch_scc1 L_1e_k0
    s_waitcnt vmcnt(4)
    v_readfirstlane_b32 s48, v148
    s_cmp_lg_u32 s57, 0
    s_cbranch_scc1 L_1v_k0
    s_add_u32 s48, s48, 832
    s_cmp_ge_u32 s48, 928
    s_cbranch_scc1 L_1v_k0
    s_mov_b32 s49, s48
    s_lshl_b32 s48, s48, 1
    s_lshr_b32 s31, s48, 3
    s_and_b32 s31, s31, 0x70
    s_xor_b32 s32, s48, s31
    s_bfe_u32 s31, s32, 0x40000
    s_lshl_b32 s52, s31, 8
    s_bfe_u32 s31, s32, 0x10004
    s_lshl_b32 s31, s31, 21
    s_or_b32 s52, s52, s31
    s_bfe_u32 s31, s32, 0x10005
    s_lshl_b32 s31, s31, 14
    s_or_b32 s52, s52, s31
    s_bfe_u32 s31, s32, 0x40006
    s_lshl_b32 s31, s31, 17
    s_or_b32 s52, s52, s31
    s_bfe_u32 s31, s32, 0x1000a
    s_lshl_b32 s31, s31, 22
    s_or_b32 s52, s52, s31
    s_mov_b32 m0, s59
    s_mov_b32 s61, 0
    v_writelane_b32 v153, s52, m0
    s_add_u32 s59, s59, 1
    s_branch L_1k_k0
L_1v_k0:
    s_mov_b32 s57, 1
    s_cmp_ge_u32 s60, s59
    s_cbranch_scc1 L_1f_k0
    v_readlane_b32 s52, v153, s60
    s_add_u32 s60, s60, 1
    s_mov_b32 s61, 1
    s_waitcnt vmcnt(0)
    s_nop 1
    buffer_load_dwordx4 v[52:55], v5, s[44:47], s52 offen offset:0 nt
    s_add_u32 s56, s52, 0x1000
    buffer_load_dwordx4 v[56:59], v5, s[44:47], s56 offen offset:0 nt
    s_add_u32 s56, s52, 0x2000
    buffer_load_dwordx4 v[60:63], v5, s[44:47], s56 offen offset:0 nt
    s_add_u32 s56, s52, 0x3000
    buffer_load_dwordx4 v[64:67], v5, s[44:47], s56 offen offset:0 nt
    s_branch L_1e_k0
L_1d_k0:
    s_mov_b32 s62, 1
    s_mov_b32 s61, 3
    s_waitcnt vmcnt(0)
    s_branch L_1e_k0
L_1f_k0:
    s_add_u32 s48, s48, 1856
    s_cmp_ge_u32 s48, 2048
    s_cbranch_scc1 L_1d_k0
    s_lshr_b32 s31, s48, 3
    s_and_b32 s31, s31, 0x70
    s_xor_b32 s32, s48, s31
    s_bfe_u32 s31, s32, 0x40000
    s_lshl_b32 s52, s31, 8
    s_bfe_u32 s31, s32, 0x10004
    s_lshl_b32 s31, s31, 21
    s_or_b32 s52, s52, s31
    s_bfe_u32 s31, s32, 0x10005
    s_lshl_b32 s31, s31, 14
    s_or_b32 s52, s52, s31
    s_bfe_u32 s31, s32, 0x40006
    s_lshl_b32 s31, s31, 17
    s_or_b32 s52, s52, s31
    s_bfe_u32 s31, s32, 0x1000a
    s_lshl_b32 s31, s31, 22
    s_or_b32 s52, s52, s31
    s_mov_b32 s61, 2
L_1k_k0:
    s_waitcnt vmcnt(0)
L_1n_k0:
    buffer_load_dwordx4 v[52:55], v4, s[40:43], s52 offen offset:0 nt
    s_add_u32 s56, s52, 0x8000
    buffer_load_dwordx4 v[56:59], v4, s[40:43], s56 offen offset:0 nt
    s_add_u32 s56, s52, 0x10000
    buffer_load_dwordx4 v[60:63], v4, s[40:43], s56 offen offset:0 nt
    s_add_u32 s56, s52, 0x18000
    buffer_load_dwordx4 v[64:67], v4, s[40:43], s56 offen offset:0 nt
L_1e_k0:
    v_mfma_f32_16x16x32_bf16 v[40:43], v[16:19], v[68:71], 0
    v_mfma_f32_16x16x32_bf16 v[40:43], v[20:23], v[72:75], v[40:43]
    v_mfma_f32_16x16x32_bf16 v[40:43], v[24:27], v[76:79], v[40:43]
    v_mfma_f32_16x16x32_bf16 v[40:43], v[28:31], v[80:83], v[40:43]
    s_nop 7
    v_mov_b32_dpp v8, v40 quad_perm:[0,0,0,0] row_mask:0xf bank_mask:0xf
    v_mov_b32_dpp v9, v42 quad_perm:[2,2,2,2] row_mask:0xf bank_mask:0xf
    s_nop 0
    v_add_f32_dpp v8, v41, v8 quad_perm:[1,1,1,1] row_mask:0xf bank_mask:0xf
    v_add_f32_dpp v9, v43, v9 quad_perm:[3,3,3,3] row_mask:0xf bank_mask:0xf
    v_add_f32 v8, v8, v9
    v_cvt_pk_bf16_f32 v8, v8, v8
    v_lshlrev_b32 v8, 16, v8
    v_mul_f32 v8, 0x3db504f3, v8
    v_cvt_pk_bf16_f32 v8, v8, v8
    v_lshlrev_b32 v8, 16, v8
    ds_write_b32 v151, v8 offset:21824
    v_add_u32 v151, 128, v151
    s_cmp_lg_u32 s62, 0
    s_cbranch_scc1 L_2e_k0
    s_or_b32 s58, s52, 0x100
    s_waitcnt vmcnt(0)
L_2w_k0:
    s_cmp_lg_u32 s61, 0
    s_cbranch_scc1 L_2v_k0
    v_add_u32 v148, 64, v148
    s_cmp_lt_u32 s49, 768
    s_cbranch_scc1 L_2k_k0
    v_mov_b32 v148, 0x10000
    s_cmp_ge_u32 s59, 32
    s_cbranch_scc1 L_2k_k0
    s_mov_b64 exec, 1
    global_atomic_add v148, v154, v150, s[26:27] sc0
    s_mov_b64 exec, -1
L_2k_k0:
    buffer_load_dwordx4 v[68:71], v4, s[40:43], s58 offen offset:0 nt
    s_add_u32 s56, s58, 0x8000
    buffer_load_dwordx4 v[72:75], v4, s[40:43], s56 offen offset:0 nt
    s_add_u32 s56, s58, 0x10000
    buffer_load_dwordx4 v[76:79], v4, s[40:43], s56 offen offset:0 nt
    s_add_u32 s56, s58, 0x18000
    buffer_load_dwordx4 v[80:83], v4, s[40:43], s56 offen offset:0 nt
    s_branch L_2e_k0
L_2v_k0:
    s_cmp_lt_u32 s60, s59
    s_cbranch_scc1 L_2n_k0
    s_mov_b64 exec, 1
    global_atomic_add v148, v149, v150, s[26:27] sc0
    s_mov_b64 exec, -1
L_2n_k0:
    s_cmp_eq_u32 s61, 2
    s_cselect_b32 s58, s52, s58
    buffer_load_dwordx4 v[68:71], v5, s[44:47], s58 offen offset:0 nt
    s_add_u32 s56, s58, 0x1000
    buffer_load_dwordx4 v[72:75], v5, s[44:47], s56 offen offset:0 nt
    s_add_u32 s56, s58, 0x2000
    buffer_load_dwordx4 v[76:79], v5, s[44:47], s56 offen offset:0 nt
    s_add_u32 s56, s58, 0x3000
    buffer_load_dwordx4 v[80:83], v5, s[44:47], s56 offen offset:0 nt
L_2e_k0:
    s_mov_b32 s50, s61
L_gt1:
    s_cmp_lg_u32 s51, 0
    s_cbranch_scc1 L_gv1
    v_mfma_f32_16x16x32_bf16 v[40:43], v[16:19], v[84:87], 0
    v_mfma_f32_16x16x32_bf16 v[40:43], v[20:23], v[88:91], v[40:43]
    v_mfma_f32_16x16x32_bf16 v[40:43], v[24:27], v[92:95], v[40:43]
    v_mfma_f32_16x16x32_bf16 v[40:43], v[28:31], v[96:99], v[40:43]
    s_nop 7
    v_mov_b32_dpp v8, v40 quad_perm:[0,0,0,0] row_mask:0xf bank_mask:0xf
    v_mov_b32_dpp v9, v42 quad_perm:[2,2,2,2] row_mask:0xf bank_mask:0xf
    s_nop 0
    v_add_f32_dpp v8, v41, v8 quad_perm:[1,1,1,1] row_mask:0xf bank_mask:0xf
    v_add_f32_dpp v9, v43, v9 quad_perm:[3,3,3,3] row_mask:0xf bank_mask:0xf
    v_add_f32 v8, v8, v9
    v_cvt_pk_bf16_f32 v8, v8, v8
    v_lshlrev_b32 v8, 16, v8
    v_mul_f32 v8, 0x3db504f3, v8
    v_cvt_pk_bf16_f32 v8, v8, v8
    v_lshlrev_b32 v8, 16, v8
    ds_write_b32 v151, v8 offset:21760
    s_cmp_lg_u32 s62, 0
    s_cbranch_scc1 L_1e_k1
    s_waitcnt vmcnt(4)
    v_readfirstlane_b32 s48, v148
    s_cmp_lg_u32 s57, 0
    s_cbranch_scc1 L_1v_k1
    s_add_u32 s48, s48, 832
    s_cmp_ge_u32 s48, 928
    s_cbranch_scc1 L_1v_k1
    s_mov_b32 s49, s48
    s_lshl_b32 s48, s48, 1
    s_lshr_b32 s31, s48, 3
    s_and_b32 s31, s31, 0x70
    s_xor_b32 s32, s48, s31
    s_bfe_u32 s31, s32, 0x40000
    s_lshl_b32 s52, s31, 8
    s_bfe_u32 s31, s32, 0x10004
    s_lshl_b32 s31, s31, 21
    s_or_b32 s52, s52, s31
    s_bfe_u32 s31, s32, 0x10005
    s_lshl_b32 s31, s31, 14
    s_or_b32 s52, s52, s31
    s_bfe_u32 s31, s32, 0x40006
    s_lshl_b32 s31, s31, 17
    s_or_b32 s52, s52, s31
    s_bfe_u32 s31, s32, 0x1000a
    s_lshl_b32 s31, s31, 22
    s_or_b32 s52, s52, s31
    s_mov_b32 m0, s59
    s_mov_b32 s61, 0
    v_writelane_b32 v153, s52, m0
    s_add_u32 s59, s59, 1
    s_branch L_1k_k1
L_1v_k1:
    s_mov_b32 s57, 1
    s_cmp_ge_u32 s60, s59
    s_cbranch_scc1 L_1f_k1
    v_readlane_b32 s52, v153, s60
    s_add_u32 s60, s60, 1
    s_mov_b32 s61, 1
    s_waitcnt vmcnt(0)
    s_nop 1
    buffer_load_dwordx4 v[84:87], v5, s[44:47], s52 offen offset:0 nt
    s_add_u32 s56, s52, 0x1000
    buffer_load_dwordx4 v[88:91], v5, s[44:47], s56 offen offset:0 nt
    s_add_u32 s56, s52, 0x2000
    buffer_load_dwordx4 v[92:95], v5, s[44:47], s56 offen offset:0 nt
    s_add_u32 s56, s52, 0x3000
    buffer_load_dwordx4 v[96:99], v5, s[44:47], s56 offen offset:0 nt
    s_branch L_1e_k1
L_1d_k1:
    s_mov_b32 s62, 1
    s_mov_b32 s61, 3
    s_waitcnt vmcnt(0)
    s_branch L_1e_k1
L_1f_k1:
    s_add_u32 s48, s48, 1856
    s_cmp_ge_u32 s48, 2048
    s_cbranch_scc1 L_1d_k1
    s_lshr_b32 s31, s48, 3
    s_and_b32 s31, s31, 0x70
    s_xor_b32 s32, s48, s31
    s_bfe_u32 s31, s32, 0x40000
    s_lshl_b32 s52, s31, 8
    s_bfe_u32 s31, s32, 0x10004
    s_lshl_b32 s31, s31, 21
    s_or_b32 s52, s52, s31
    s_bfe_u32 s31, s32, 0x10005
    s_lshl_b32 s31, s31, 14
    s_or_b32 s52, s52, s31
    s_bfe_u32 s31, s32, 0x40006
    s_lshl_b32 s31, s31, 17
    s_or_b32 s52, s52, s31
    s_bfe_u32 s31, s32, 0x1000a
    s_lshl_b32 s31, s31, 22
    s_or_b32 s52, s52, s31
    s_mov_b32 s61, 2
L_1k_k1:
    s_waitcnt vmcnt(0)
L_1n_k1:
    buffer_load_dwordx4 v[84:87], v4, s[40:43], s52 offen offset:0 nt
    s_add_u32 s56, s52, 0x8000
    buffer_load_dwordx4 v[88:91], v4, s[40:43], s56 offen offset:0 nt
    s_add_u32 s56, s52, 0x10000
    buffer_load_dwordx4 v[92:95], v4, s[40:43], s56 offen offset:0 nt
    s_add_u32 s56, s52, 0x18000
    buffer_load_dwordx4 v[96:99], v4, s[40:43], s56 offen offset:0 nt
L_1e_k1:
    v_mfma_f32_16x16x32_bf16 v[40:43], v[16:19], v[100:103], 0
    v_mfma_f32_16x16x32_bf16 v[40:43], v[20:23], v[104:107], v[40:43]
    v_mfma_f32_16x16x32_bf16 v[40:43], v[24:27], v[108:111], v[40:43]
    v_mfma_f32_16x16x32_bf16 v[40:43], v[28:31], v[112:115], v[40:43]
    s_nop 7
    v_mov_b32_dpp v8, v40 quad_perm:[0,0,0,0] row_mask:0xf bank_mask:0xf
    v_mov_b32_dpp v9, v42 quad_perm:[2,2,2,2] row_mask:0xf bank_mask:0xf
    s_nop 0
    v_add_f32_dpp v8, v41, v8 quad_perm:[1,1,1,1] row_mask:0xf bank_mask:0xf
    v_add_f32_dpp v9, v43, v9 quad_perm:[3,3,3,3] row_mask:0xf bank_mask:0xf
    v_add_f32 v8, v8, v9
    v_cvt_pk_bf16_f32 v8, v8, v8
    v_lshlrev_b32 v8, 16, v8
    v_mul_f32 v8, 0x3db504f3, v8
    v_cvt_pk_bf16_f32 v8, v8, v8
    v_lshlrev_b32 v8, 16, v8
    ds_write_b32 v151, v8 offset:21824
    v_add_u32 v151, 128, v151
    s_cmp_lg_u32 s62, 0
    s_cbranch_scc1 L_2e_k1
    s_or_b32 s58, s52, 0x100
    s_waitcnt vmcnt(0)
L_2w_k1:
    s_cmp_lg_u32 s61, 0
    s_cbranch_scc1 L_2v_k1
    v_add_u32 v148, 64, v148
    s_cmp_lt_u32 s49, 768
    s_cbranch_scc1 L_2k_k1
    v_mov_b32 v148, 0x10000
    s_cmp_ge_u32 s59, 32
    s_cbranch_scc1 L_2k_k1
    s_mov_b64 exec, 1
    global_atomic_add v148, v154, v150, s[26:27] sc0
    s_mov_b64 exec, -1
L_2k_k1:
    buffer_load_dwordx4 v[100:103], v4, s[40:43], s58 offen offset:0 nt
    s_add_u32 s56, s58, 0x8000
    buffer_load_dwordx4 v[104:107], v4, s[40:43], s56 offen offset:0 nt
    s_add_u32 s56, s58, 0x10000
    buffer_load_dwordx4 v[108:111], v4, s[40:43], s56 offen offset:0 nt
    s_add_u32 s56, s58, 0x18000
    buffer_load_dwordx4 v[112:115], v4, s[40:43], s56 offen offset:0 nt
    s_branch L_2e_k1
L_2v_k1:
    s_cmp_lt_u32 s60, s59
    s_cbranch_scc1 L_2n_k1
    s_mov_b64 exec, 1
    global_atomic_add v148, v149, v150, s[26:27] sc0
    s_mov_b64 exec, -1
L_2n_k1:
    s_cmp_eq_u32 s61, 2
    s_cselect_b32 s58, s52, s58
    buffer_load_dwordx4 v[100:103], v5, s[44:47], s58 offen offset:0 nt
    s_add_u32 s56, s58, 0x1000
    buffer_load_dwordx4 v[104:107], v5, s[44:47], s56 offen offset:0 nt
    s_add_u32 s56, s58, 0x2000
    buffer_load_dwordx4 v[108:111], v5, s[44:47], s56 offen offset:0 nt
    s_add_u32 s56, s58, 0x3000
    buffer_load_dwordx4 v[112:115], v5, s[44:47], s56 offen offset:0 nt
L_2e_k1:
    s_mov_b32 s51, s61
    s_branch L_gt0
L_gv0:
    s_cmp_lg_u32 s50, 1
    s_cbranch_scc1 L_gf0
    ds_read_b32 v8, v152 offset:21760
    s_waitcnt lgkmcnt(0)
    v_cmp_gt_f32 vcc, v8, v6
    s_cbranch_vccnz L_resc_u0
L_back_u0:
    v_sub_f32 v9, v8, v6
    v_mul_f32 v9, 0x3fb8aa3b, v9
    v_exp_f32 v9, v9
    s_nop 0
    v_add_f32 v7, v7, v9
    v_cvt_pk_bf16_f32 v9, v9, v9
    v_and_b32 v44, v9, v12
    v_and_b32 v45, v9, v13
    v_and_b32_dpp v46, v9, v14 row_ror:4 row_mask:0xf bank_mask:0xf
    v_and_b32_dpp v47, v9, v15 row_ror:4 row_mask:0xf bank_mask:0xf
    v_and_b32_dpp v48, v9, v12 row_ror:12 row_mask:0xf bank_mask:0xf
    v_and_b32_dpp v49, v9, v13 row_ror:12 row_mask:0xf bank_mask:0xf
    v_and_b32 v50, v9, v14
    v_and_b32 v51, v9, v15
    s_waitcnt vmcnt(12)
    v_mfma_f32_16x16x32_bf16 v[32:35], v[44:47], v[52:55], v[32:35]
    v_mfma_f32_16x16x32_bf16 v[36:39], v[44:47], v[60:63], v[36:39]
    v_mfma_f32_16x16x32_bf16 v[32:35], v[48:51], v[56:59], v[32:35]
    v_mfma_f32_16x16x32_bf16 v[36:39], v[48:51], v[64:67], v[36:39]
    s_cmp_lg_u32 s62, 0
    s_cbranch_scc1 L_1e_v0
    s_waitcnt vmcnt(4)
    v_readfirstlane_b32 s48, v148
    s_cmp_ge_u32 s60, s59
    s_cbranch_scc1 L_1f_v0
    v_readlane_b32 s52, v153, s60
    s_add_u32 s60, s60, 1
    s_mov_b32 s61, 1
    s_waitcnt vmcnt(0)
    s_nop 1
    buffer_load_dwordx4 v[52:55], v5, s[44:47], s52 offen offset:0 nt
    s_add_u32 s56, s52, 0x1000
    buffer_load_dwordx4 v[56:59], v5, s[44:47], s56 offen offset:0 nt
    s_add_u32 s56, s52, 0x2000
    buffer_load_dwordx4 v[60:63], v5, s[44:47], s56 offen offset:0 nt
    s_add_u32 s56, s52, 0x3000
    buffer_load_dwordx4 v[64:67], v5, s[44:47], s56 offen offset:0 nt
    s_branch L_1e_v0
L_1d_v0:
    s_mov_b32 s62, 1
    s_mov_b32 s61, 3
    s_waitcnt vmcnt(0)
    s_branch L_1e_v0
L_1f_v0:
    s_add_u32 s48, s48, 1856
    s_cmp_ge_u32 s48, 2048
    s_cbranch_scc1 L_1d_v0
    s_lshr_b32 s31, s48, 3
    s_and_b32 s31, s31, 0x70
    s_xor_b32 s32, s48, s31
    s_bfe_u32 s31, s32, 0x40000
    s_lshl_b32 s52, s31, 8
    s_bfe_u32 s31, s32, 0x10004
    s_lshl_b32 s31, s31, 21
    s_or_b32 s52, s52, s31
    s_bfe_u32 s31, s32, 0x10005
    s_lshl_b32 s31, s31, 14
    s_or_b32 s52, s52, s31
    s_bfe_u32 s31, s32, 0x40006
    s_lshl_b32 s31, s31, 17
    s_or_b32 s52, s52, s31
    s_bfe_u32 s31, s32, 0x1000a
    s_lshl_b32 s31, s31, 22
    s_or_b32 s52, s52, s31
    s_mov_b32 s61, 2
L_1k_v0:
    s_waitcnt vmcnt(0)
L_1n_v0:
    buffer_load_dwordx4 v[52:55], v4, s[40:43], s52 offen offset:0 nt
    s_add_u32 s56, s52, 0x8000
    buffer_load_dwordx4 v[56:59], v4, s[40:43], s56 offen offset:0 nt
    s_add_u32 s56, s52, 0x10000
    buffer_load_dwordx4 v[60:63], v4, s[40:43], s56 offen offset:0 nt
    s_add_u32 s56, s52, 0x18000
    buffer_load_dwordx4 v[64:67], v4, s[40:43], s56 offen offset:0 nt
L_1e_v0:
    ds_read_b32 v8, v152 offset:21824
    s_waitcnt lgkmcnt(0)
    v_cmp_gt_f32 vcc, v8, v6
    s_cbranch_vccnz L_resc_w0
L_back_w0:
    v_sub_f32 v9, v8, v6
    v_mul_f32 v9, 0x3fb8aa3b, v9
    v_exp_f32 v9, v9
    s_nop 0
    v_add_f32 v7, v7, v9
    v_cvt_pk_bf16_f32 v9, v9, v9
    v_and_b32 v44, v9, v12
    v_and_b32 v45, v9, v13
    v_and_b32_dpp v46, v9, v14 row_ror:4 row_mask:0xf bank_mask:0xf
    v_and_b32_dpp v47, v9, v15 row_ror:4 row_mask:0xf bank_mask:0xf
    v_and_b32_dpp v48, v9, v12 row_ror:12 row_mask:0xf bank_mask:0xf
    v_and_b32_dpp v49, v9, v13 row_ror:12 row_mask:0xf bank_mask:0xf
    v_and_b32 v50, v9, v14
    v_and_b32 v51, v9, v15
    s_waitcnt vmcnt(12)
    v_mfma_f32_16x16x32_bf16 v[32:35], v[44:47], v[68:71], v[32:35]
    v_mfma_f32_16x16x32_bf16 v[36:39], v[44:47], v[76:79], v[36:39]
    v_mfma_f32_16x16x32_bf16 v[32:35], v[48:51], v[72:75], v[32:35]
    v_mfma_f32_16x16x32_bf16 v[36:39], v[48:51], v[80:83], v[36:39]
    v_add_u32 v152, 128, v152
    s_cmp_lg_u32 s62, 0
    s_cbranch_scc1 L_2e_v0
    s_or_b32 s58, s52, 0x100
    s_waitcnt vmcnt(0)
L_2w_v0:
    s_cmp_lt_u32 s60, s59
    s_cbranch_scc1 L_2n_v0
    s_mov_b64 exec, 1
    global_atomic_add v148, v149, v150, s[26:27] sc0
    s_mov_b64 exec, -1
L_2n_v0:
    s_cmp_eq_u32 s61, 2
    s_cselect_b32 s58, s52, s58
    buffer_load_dwordx4 v[68:71], v5, s[44:47], s58 offen offset:0 nt
    s_add_u32 s56, s58, 0x1000
    buffer_load_dwordx4 v[72:75], v5, s[44:47], s56 offen offset:0 nt
    s_add_u32 s56, s58, 0x2000
    buffer_load_dwordx4 v[76:79], v5, s[44:47], s56 offen offset:0 nt
    s_add_u32 s56, s58, 0x3000
    buffer_load_dwordx4 v[80:83], v5, s[44:47], s56 offen offset:0 nt
L_2e_v0:
    s_mov_b32 s50, s61
L_gv1:
    s_cmp_lg_u32 s51, 1
    s_cbranch_scc1 L_gf1
    ds_read_b32 v8, v152 offset:21760
    s_waitcnt lgkmcnt(0)
    v_cmp_gt_f32 vcc, v8, v6
    s_cbranch_vccnz L_resc_u1
L_back_u1:
    v_sub_f32 v9, v8, v6
    v_mul_f32 v9, 0x3fb8aa3b, v9
    v_exp_f32 v9, v9
    s_nop 0
    v_add_f32 v7, v7, v9
    v_cvt_pk_bf16_f32 v9, v9, v9
    v_and_b32 v44, v9, v12
    v_and_b32 v45, v9, v13
    v_and_b32_dpp v46, v9, v14 row_ror:4 row_mask:0xf bank_mask:0xf
    v_and_b32_dpp v47, v9, v15 row_ror:4 row_mask:0xf bank_mask:0xf
    v_and_b32_dpp v48, v9, v12 row_ror:12 row_mask:0xf bank_mask:0xf
    v_and_b32_dpp v49, v9, v13 row_ror:12 row_mask:0xf bank_mask:0xf
    v_and_b32 v50, v9, v14
    v_and_b32 v51, v9, v15
    s_waitcnt vmcnt(12)
    v_mfma_f32_16x16x32_bf16 v[32:35], v[44:47], v[84:87], v[32:35]
    v_mfma_f32_16x16x32_bf16 v[36:39], v[44:47], v[92:95], v[36:39]
    v_mfma_f32_16x16x32_bf16 v[32:35], v[48:51], v[88:91], v[32:35]
    v_mfma_f32_16x16x32_bf16 v[36:39], v[48:51], v[96:99], v[36:39]
    s_cmp_lg_u32 s62, 0
    s_cbranch_scc1 L_1e_v1
    s_waitcnt vmcnt(4)
    v_readfirstlane_b32 s48, v148
    s_cmp_ge_u32 s60, s59
    s_cbranch_scc1 L_1f_v1
    v_readlane_b32 s52, v153, s60
    s_add_u32 s60, s60, 1
    s_mov_b32 s61, 1
    s_waitcnt vmcnt(0)
    s_nop 1
    buffer_load_dwordx4 v[84:87], v5, s[44:47], s52 offen offset:0 nt
    s_add_u32 s56, s52, 0x1000
    buffer_load_dwordx4 v[88:91], v5, s[44:47], s56 offen offset:0 nt
    s_add_u32 s56, s52, 0x2000
    buffer_load_dwordx4 v[92:95], v5, s[44:47], s56 offen offset:0 nt
    s_add_u32 s56, s52, 0x3000
    buffer_load_dwordx4 v[96:99], v5, s[44:47], s56 offen offset:0 nt
    s_branch L_1e_v1
L_1d_v1:
    s_mov_b32 s62, 1
    s_mov_b32 s61, 3
    s_waitcnt vmcnt(0)
    s_branch L_1e_v1
L_1f_v1:
    s_add_u32 s48, s48, 1856
    s_cmp_ge_u32 s48, 2048
    s_cbranch_scc1 L_1d_v1
    s_lshr_b32 s31, s48, 3
    s_and_b32 s31, s31, 0x70
    s_xor_b32 s32, s48, s31
    s_bfe_u32 s31, s32, 0x40000
    s_lshl_b32 s52, s31, 8
    s_bfe_u32 s31, s32, 0x10004
    s_lshl_b32 s31, s31, 21
    s_or_b32 s52, s52, s31
    s_bfe_u32 s31, s32, 0x10005
    s_lshl_b32 s31, s31, 14
    s_or_b32 s52, s52, s31
    s_bfe_u32 s31, s32, 0x40006
    s_lshl_b32 s31, s31, 17
    s_or_b32 s52, s52, s31
    s_bfe_u32 s31, s32, 0x1000a
    s_lshl_b32 s31, s31, 22
    s_or_b32 s52, s52, s31
    s_mov_b32 s61, 2
L_1k_v1:
    s_waitcnt vmcnt(0)
L_1n_v1:
    buffer_load_dwordx4 v[84:87], v4, s[40:43], s52 offen offset:0 nt
    s_add_u32 s56, s52, 0x8000
    buffer_load_dwordx4 v[88:91], v4, s[40:43], s56 offen offset:0 nt
    s_add_u32 s56, s52, 0x10000
    buffer_load_dwordx4 v[92:95], v4, s[40:43], s56 offen offset:0 nt
    s_add_u32 s56, s52, 0x18000
    buffer_load_dwordx4 v[96:99], v4, s[40:43], s56 offen offset:0 nt
L_1e_v1:
    ds_read_b32 v8, v152 offset:21824
    s_waitcnt lgkmcnt(0)
    v_cmp_gt_f32 vcc, v8, v6
    s_cbranch_vccnz L_resc_w1
L_back_w1:
    v_sub_f32 v9, v8, v6
    v_mul_f32 v9, 0x3fb8aa3b, v9
    v_exp_f32 v9, v9
    s_nop 0
    v_add_f32 v7, v7, v9
    v_cvt_pk_bf16_f32 v9, v9, v9
    v_and_b32 v44, v9, v12
    v_and_b32 v45, v9, v13
    v_and_b32_dpp v46, v9, v14 row_ror:4 row_mask:0xf bank_mask:0xf
    v_and_b32_dpp v47, v9, v15 row_ror:4 row_mask:0xf bank_mask:0xf
    v_and_b32_dpp v48, v9, v12 row_ror:12 row_mask:0xf bank_mask:0xf
    v_and_b32_dpp v49, v9, v13 row_ror:12 row_mask:0xf bank_mask:0xf
    v_and_b32 v50, v9, v14
    v_and_b32 v51, v9, v15
    s_waitcnt vmcnt(12)
    v_mfma_f32_16x16x32_bf16 v[32:35], v[44:47], v[100:103], v[32:35]
    v_mfma_f32_16x16x32_bf16 v[36:39], v[44:47], v[108:111], v[36:39]
    v_mfma_f32_16x16x32_bf16 v[32:35], v[48:51], v[104:107], v[32:35]
    v_mfma_f32_16x16x32_bf16 v[36:39], v[48:51], v[112:115], v[36:39]
    v_add_u32 v152, 128, v152
    s_cmp_lg_u32 s62, 0
    s_cbranch_scc1 L_2e_v1
    s_or_b32 s58, s52, 0x100
    s_waitcnt vmcnt(0)
L_2w_v1:
    s_cmp_lt_u32 s60, s59
    s_cbranch_scc1 L_2n_v1
    s_mov_b64 exec, 1
    global_atomic_add v148, v149, v150, s[26:27] sc0
    s_mov_b64 exec, -1
L_2n_v1:
    s_cmp_eq_u32 s61, 2
    s_cselect_b32 s58, s52, s58
    buffer_load_dwordx4 v[100:103], v5, s[44:47], s58 offen offset:0 nt
    s_add_u32 s56, s58, 0x1000
    buffer_load_dwordx4 v[104:107], v5, s[44:47], s56 offen offset:0 nt
    s_add_u32 s56, s58, 0x2000
    buffer_load_dwordx4 v[108:111], v5, s[44:47], s56 offen offset:0 nt
    s_add_u32 s56, s58, 0x3000
    buffer_load_dwordx4 v[112:115], v5, s[44:47], s56 offen offset:0 nt
L_2e_v1:
    s_mov_b32 s51, s61
    s_branch L_gv0
L_gf0:
    s_cmp_eq_u32 s50, 3
    s_cbranch_scc1 L_exit
    s_cmp_eq_u32 s62, 0
    s_cbranch_scc1 L_body_a0
    v_mfma_f32_16x16x32_bf16 v[40:43], v[16:19], v[52:55], 0
    v_mfma_f32_16x16x32_bf16 v[40:43], v[20:23], v[56:59], v[40:43]
    v_mfma_f32_16x16x32_bf16 v[40:43], v[24:27], v[60:63], v[40:43]
    v_mfma_f32_16x16x32_bf16 v[40:43], v[28:31], v[64:67], v[40:43]
    s_nop 7
    v_mov_b32_dpp v8, v40 quad_perm:[0,0,0,0] row_mask:0xf bank_mask:0xf
    v_mov_b32_dpp v9, v42 quad_perm:[2,2,2,2] row_mask:0xf bank_mask:0xf
    s_nop 0
    v_add_f32_dpp v8, v41, v8 quad_perm:[1,1,1,1] row_mask:0xf bank_mask:0xf
    v_add_f32_dpp v9, v43, v9 quad_perm:[3,3,3,3] row_mask:0xf bank_mask:0xf
    v_add_f32 v8, v8, v9
    v_cvt_pk_bf16_f32 v8, v8, v8
    v_lshlrev_b32 v8, 16, v8
    v_mul_f32 v8, 0x3db504f3, v8
    v_cvt_pk_bf16_f32 v8, v8, v8
    v_lshlrev_b32 v8, 16, v8
    v_cmp_gt_f32 vcc, v8, v6
    s_cbranch_vccnz L_resc_z0
L_back_z0:
    v_sub_f32 v9, v8, v6
    v_mul_f32 v9, 0x3fb8aa3b, v9
    v_exp_f32 v9, v9
    s_nop 0
    v_add_f32 v7, v7, v9
    v_cvt_pk_bf16_f32 v9, v9, v9
    v_and_b32 v44, v9, v12
    v_and_b32 v45, v9, v13
    v_and_b32_dpp v46, v9, v14 row_ror:4 row_mask:0xf bank_mask:0xf
    v_and_b32_dpp v47, v9, v15 row_ror:4 row_mask:0xf bank_mask:0xf
    v_and_b32_dpp v48, v9, v12 row_ror:12 row_mask:0xf bank_mask:0xf
    v_and_b32_dpp v49, v9, v13 row_ror:12 row_mask:0xf bank_mask:0xf
    v_and_b32 v50, v9, v14
    v_and_b32 v51, v9, v15
    s_waitcnt vmcnt(0)
    v_mfma_f32_16x16x32_bf16 v[32:35], v[44:47], v[68:71], v[32:35]
    v_mfma_f32_16x16x32_bf16 v[36:39], v[44:47], v[76:79], v[36:39]
    v_mfma_f32_16x16x32_bf16 v[32:35], v[48:51], v[72:75], v[32:35]
    v_mfma_f32_16x16x32_bf16 v[36:39], v[48:51], v[80:83], v[36:39]
    s_branch L_exit
L_gf1:
    s_cmp_eq_u32 s51, 3
    s_cbranch_scc1 L_exit
    s_cmp_eq_u32 s62, 0
    s_cbranch_scc1 L_body_a1
    v_mfma_f32_16x16x32_bf16 v[40:43], v[16:19], v[84:87], 0
    v_mfma_f32_16x16x32_bf16 v[40:43], v[20:23], v[88:91], v[40:43]
    v_mfma_f32_16x16x32_bf16 v[40:43], v[24:27], v[92:95], v[40:43]
    v_mfma_f32_16x16x32_bf16 v[40:43], v[28:31], v[96:99], v[40:43]
    s_nop 7
    v_mov_b32_dpp v8, v40 quad_perm:[0,0,0,0] row_mask:0xf bank_mask:0xf
    v_mov_b32_dpp v9, v42 quad_perm:[2,2,2,2] row_mask:0xf bank_mask:0xf
    s_nop 0
    v_add_f32_dpp v8, v41, v8 quad_perm:[1,1,1,1] row_mask:0xf bank_mask:0xf
    v_add_f32_dpp v9, v43, v9 quad_perm:[3,3,3,3] row_mask:0xf bank_mask:0xf
    v_add_f32 v8, v8, v9
    v_cvt_pk_bf16_f32 v8, v8, v8
    v_lshlrev_b32 v8, 16, v8
    v_mul_f32 v8, 0x3db504f3, v8
    v_cvt_pk_bf16_f32 v8, v8, v8
    v_lshlrev_b32 v8, 16, v8
    v_cmp_gt_f32 vcc, v8, v6
    s_cbranch_vccnz L_resc_z1
L_back_z1:
    v_sub_f32 v9, v8, v6
    v_mul_f32 v9, 0x3fb8aa3b, v9
    v_exp_f32 v9, v9
    s_nop 0
    v_add_f32 v7, v7, v9
    v_cvt_pk_bf16_f32 v9, v9, v9
    v_and_b32 v44, v9, v12
    v_and_b32 v45, v9, v13
    v_and_b32_dpp v46, v9, v14 row_ror:4 row_mask:0xf bank_mask:0xf
    v_and_b32_dpp v47, v9, v15 row_ror:4 row_mask:0xf bank_mask:0xf
    v_and_b32_dpp v48, v9, v12 row_ror:12 row_mask:0xf bank_mask:0xf
    v_and_b32_dpp v49, v9, v13 row_ror:12 row_mask:0xf bank_mask:0xf
    v_and_b32 v50, v9, v14
    v_and_b32 v51, v9, v15
    s_waitcnt vmcnt(0)
    v_mfma_f32_16x16x32_bf16 v[32:35], v[44:47], v[100:103], v[32:35]
    v_mfma_f32_16x16x32_bf16 v[36:39], v[44:47], v[108:111], v[36:39]
    v_mfma_f32_16x16x32_bf16 v[32:35], v[48:51], v[104:107], v[32:35]
    v_mfma_f32_16x16x32_bf16 v[36:39], v[48:51], v[112:115], v[36:39]
    s_branch L_exit
L_loopa:
L_body_a0:
    s_waitcnt vmcnt(12)
    v_mfma_f32_16x16x32_bf16 v[40:43], v[16:19], v[52:55], 0
    v_mfma_f32_16x16x32_bf16 v[40:43], v[20:23], v[56:59], v[40:43]
    v_mfma_f32_16x16x32_bf16 v[40:43], v[24:27], v[60:63], v[40:43]
    v_mfma_f32_16x16x32_bf16 v[40:43], v[28:31], v[64:67], v[40:43]
    s_waitcnt vmcnt(4)
    v_readfirstlane_b32 s48, v148
    s_add_u32 s48, s48, 1856
    s_and_b32 s48, s48, 0xffff
    s_cmp_ge_u32 s48, 1920
    s_cbranch_scc1 L_chk_b0
L_go_a0:
    s_lshr_b32 s31, s48, 3
    s_and_b32 s31, s31, 0x70
    s_xor_b32 s32, s48, s31
    s_bfe_u32 s31, s32, 0x40000
    s_lshl_b32 s52, s31, 8
    s_bfe_u32 s31, s32, 0x10004
    s_lshl_b32 s31, s31, 21
    s_or_b32 s52, s52, s31
    s_bfe_u32 s31, s32, 0x10005
    s_lshl_b32 s31, s31, 14
    s_or_b32 s52, s52, s31
    s_bfe_u32 s31, s32, 0x40006
    s_lshl_b32 s31, s31, 17
    s_or_b32 s52, s52, s31
    s_bfe_u32 s31, s32, 0x1000a
    s_lshl_b32 s31, s31, 22
    s_or_b32 s52, s52, s31
    s_waitcnt vmcnt(0)
    buffer_load_dwordx4 v[52:55], v4, s[40:43], s52 offen offset:0 nt
    s_add_u32 s56, s52, 0x8000
    buffer_load_dwordx4 v[56:59], v4, s[40:43], s56 offen offset:0 nt
    s_add_u32 s56, s52, 0x10000
    buffer_load_dwordx4 v[60:63], v4, s[40:43], s56 offen offset:0 nt
    s_add_u32 s56, s52, 0x18000
    buffer_load_dwordx4 v[64:67], v4, s[40:43], s56 offen offset:0 nt
    v_mov_b32_dpp v8, v40 quad_perm:[0,0,0,0] row_mask:0xf bank_mask:0xf
    v_mov_b32_dpp v9, v42 quad_perm:[2,2,2,2] row_mask:0xf bank_mask:0xf
    s_nop 0
    v_add_f32_dpp v8, v41, v8 quad_perm:[1,1,1,1] row_mask:0xf bank_mask:0xf
    v_add_f32_dpp v9, v43, v9 quad_perm:[3,3,3,3] row_mask:0xf bank_mask:0xf
    v_add_f32 v8, v8, v9
    v_cvt_pk_bf16_f32 v8, v8, v8
    v_lshlrev_b32 v8, 16, v8
    v_mul_f32 v8, 0x3db504f3, v8
    v_cvt_pk_bf16_f32 v8, v8, v8
    v_lshlrev_b32 v8, 16, v8
    v_cmp_gt_f32 vcc, v8, v6
    s_cbranch_vccnz L_resc_a0
L_back_a0:
    v_sub_f32 v9, v8, v6
    v_mul_f32 v9, 0x3fb8aa3b, v9
    v_exp_f32 v9, v9
    s_nop 0
    v_add_f32 v7, v7, v9
    v_cvt_pk_bf16_f32 v9, v9, v9
    v_and_b32 v44, v9, v12
    v_and_b32 v45, v9, v13
    v_and_b32_dpp v46, v9, v14 row_ror:4 row_mask:0xf bank_mask:0xf
    v_and_b32_dpp v47, v9, v15 row_ror:4 row_mask:0xf bank_mask:0xf
    v_and_b32_dpp v48, v9, v12 row_ror:12 row_mask:0xf bank_mask:0xf
    v_and_b32_dpp v49, v9, v13 row_ror:12 row_mask:0xf bank_mask:0xf
    v_and_b32 v50, v9, v14
    v_and_b32 v51, v9, v15
    s_waitcnt vmcnt(12)
    v_mfma_f32_16x16x32_bf16 v[32:35], v[44:47], v[68:71], v[32:35]
    v_mfma_f32_16x16x32_bf16 v[36:39], v[44:47], v[76:79], v[36:39]
    v_mfma_f32_16x16x32_bf16 v[32:35], v[48:51], v[72:75], v[32:35]
    v_mfma_f32_16x16x32_bf16 v[36:39], v[48:51], v[80:83], v[36:39]
    s_waitcnt vmcnt(0)
    s_mov_b64 exec, 1
    global_atomic_add v148, v149, v150, s[26:27] sc0
    s_mov_b64 exec, -1
    buffer_load_dwordx4 v[68:71], v5, s[44:47], s52 offen offset:0 nt
    s_add_u32 s56, s52, 0x1000
    buffer_load_dwordx4 v[72:75], v5, s[44:47], s56 offen offset:0 nt
    s_add_u32 s56, s52, 0x2000
    buffer_load_dwordx4 v[76:79], v5, s[44:47], s56 offen offset:0 nt
    s_add_u32 s56, s52, 0x3000
    buffer_load_dwordx4 v[80:83], v5, s[44:47], s56 offen offset:0 nt
L_body_a1:
    s_waitcnt vmcnt(12)
    v_mfma_f32_16x16x32_bf16 v[40:43], v[16:19], v[84:87], 0
    v_mfma_f32_16x16x32_bf16 v[40:43], v[20:23], v[88:91], v[40:43]
    v_mfma_f32_16x16x32_bf16 v[40:43], v[24:27], v[92:95], v[40:43]
    v_mfma_f32_16x16x32_bf16 v[40:43], v[28:31], v[96:99], v[40:43]
    s_waitcnt vmcnt(4)
    v_readfirstlane_b32 s48, v148
    s_add_u32 s48, s48, 1856
    s_and_b32 s48, s48, 0xffff
    s_cmp_ge_u32 s48, 1920
    s_cbranch_scc1 L_chk_b1
L_go_a1:
    s_lshr_b32 s31, s48, 3
    s_and_b32 s31, s31, 0x70
    s_xor_b32 s32, s48, s31
    s_bfe_u32 s31, s32, 0x40000
    s_lshl_b32 s52, s31, 8
    s_bfe_u32 s31, s32, 0x10004
    s_lshl_b32 s31, s31, 21
    s_or_b32 s52, s52, s31
    s_bfe_u32 s31, s32, 0x10005
    s_lshl_b32 s31, s31, 14
    s_or_b32 s52, s52, s31
    s_bfe_u32 s31, s32, 0x40006
    s_lshl_b32 s31, s31, 17
    s_or_b32 s52, s52, s31
    s_bfe_u32 s31, s32, 0x1000a
    s_lshl_b32 s31, s31, 22
    s_or_b32 s52, s52, s31
    s_waitcnt vmcnt(0)
    buffer_load_dwordx4 v[84:87], v4, s[40:43], s52 offen offset:0 nt
    s_add_u32 s56, s52, 0x8000
    buffer_load_dwordx4 v[88:91], v4, s[40:43], s56 offen offset:0 nt
    s_add_u32 s56, s52, 0x10000
    buffer_load_dwordx4 v[92:95], v4, s[40:43], s56 offen offset:0 nt
    s_add_u32 s56, s52, 0x18000
    buffer_load_dwordx4 v[96:99], v4, s[40:43], s56 offen offset:0 nt
    v_mov_b32_dpp v8, v40 quad_perm:[0,0,0,0] row_mask:0xf bank_mask:0xf
    v_mov_b32_dpp v9, v42 quad_perm:[2,2,2,2] row_mask:0xf bank_mask:0xf
    s_nop 0
    v_add_f32_dpp v8, v41, v8 quad_perm:[1,1,1,1] row_mask:0xf bank_mask:0xf
    v_add_f32_dpp v9, v43, v9 quad_perm:[3,3,3,3] row_mask:0xf bank_mask:0xf
    v_add_f32 v8, v8, v9
    v_cvt_pk_bf16_f32 v8, v8, v8
    v_lshlrev_b32 v8, 16, v8
    v_mul_f32 v8, 0x3db504f3, v8
    v_cvt_pk_bf16_f32 v8, v8, v8
    v_lshlrev_b32 v8, 16, v8
    v_cmp_gt_f32 vcc, v8, v6
    s_cbranch_vccnz L_resc_a1
L_back_a1:
    v_sub_f32 v9, v8, v6
    v_mul_f32 v9, 0x3fb8aa3b, v9
    v_exp_f32 v9, v9
    s_nop 0
    v_add_f32 v7, v7, v9
    v_cvt_pk_bf16_f32 v9, v9, v9
    v_and_b32 v44, v9, v12
    v_and_b32 v45, v9, v13
    v_and_b32_dpp v46, v9, v14 row_ror:4 row_mask:0xf bank_mask:0xf
    v_and_b32_dpp v47, v9, v15 row_ror:4 row_mask:0xf bank_mask:0xf
    v_and_b32_dpp v48, v9, v12 row_ror:12 row_mask:0xf bank_mask:0xf
    v_and_b32_dpp v49, v9, v13 row_ror:12 row_mask:0xf bank_mask:0xf
    v_and_b32 v50, v9, v14
    v_and_b32 v51, v9, v15
    s_waitcnt vmcnt(12)
    v_mfma_f32_16x16x32_bf16 v[32:35], v[44:47], v[100:103], v[32:35]
    v_mfma_f32_16x16x32_bf16 v[36:39], v[44:47], v[108:111], v[36:39]
    v_mfma_f32_16x16x32_bf16 v[32:35], v[48:51], v[104:107], v[32:35]
    v_mfma_f32_16x16x32_bf16 v[36:39], v[48:51], v[112:115], v[36:39]
    s_waitcnt vmcnt(0)
    s_mov_b64 exec, 1
    global_atomic_add v148, v149, v150, s[26:27] sc0
    s_mov_b64 exec, -1
    buffer_load_dwordx4 v[100:103], v5, s[44:47], s52 offen offset:0 nt
    s_add_u32 s56, s52, 0x1000
    buffer_load_dwordx4 v[104:107], v5, s[44:47], s56 offen offset:0 nt
    s_add_u32 s56, s52, 0x2000
    buffer_load_dwordx4 v[108:111], v5, s[44:47], s56 offen offset:0 nt
    s_add_u32 s56, s52, 0x3000
    buffer_load_dwordx4 v[112:115], v5, s[44:47], s56 offen offset:0 nt
    s_branch L_loopa
L_loopb:
L_body_b0:
    s_waitcnt vmcnt(12)
    v_mfma_f32_16x16x32_bf16 v[40:43], v[16:19], v[52:55], 0
    v_mfma_f32_16x16x32_bf16 v[40:43], v[20:23], v[56:59], v[40:43]
    v_mfma_f32_16x16x32_bf16 v[40:43], v[24:27], v[60:63], v[40:43]
    v_mfma_f32_16x16x32_bf16 v[40:43], v[28:31], v[64:67], v[40:43]
    s_waitcnt vmcnt(8)
    v_readfirstlane_b32 s48, v148
    s_add_u32 s48, s48, 1856
    s_and_b32 s48, s48, 0xffff
L_chk_b0:
    s_cmp_ge_u32 s48, 2048
    s_cbranch_scc1 L_drain0
L_go_b0:
    s_lshr_b32 s31, s48, 3
    s_and_b32 s31, s31, 0x70
    s_xor_b32 s32, s48, s31
    s_bfe_u32 s31, s32, 0x40000
    s_lshl_b32 s52, s31, 8
    s_bfe_u32 s31, s32, 0x10004
    s_lshl_b32 s31, s31, 21
    s_or_b32 s52, s52, s31
    s_bfe_u32 s31, s32, 0x10005
    s_lshl_b32 s31, s31, 14
    s_or_b32 s52, s52, s31
    s_bfe_u32 s31, s32, 0x40006
    s_lshl_b32 s31, s31, 17
    s_or_b32 s52, s52, s31
    s_bfe_u32 s31, s32, 0x1000a
    s_lshl_b32 s31, s31, 22
    s_or_b32 s52, s52, s31
    s_mov_b64 exec, 1
    global_atomic_add v148, v149, v150, s[26:27] sc0
    s_mov_b64 exec, -1
    buffer_load_dwordx4 v[52:55], v4, s[40:43], s52 offen offset:0 nt
    s_add_u32 s56, s52, 0x8000
    buffer_load_dwordx4 v[56:59], v4, s[40:43], s56 offen offset:0 nt
    s_add_u32 s56, s52, 0x10000
    buffer_load_dwordx4 v[60:63], v4, s[40:43], s56 offen offset:0 nt
    s_add_u32 s56, s52, 0x18000
    buffer_load_dwordx4 v[64:67], v4, s[40:43], s56 offen offset:0 nt
    v_mov_b32_dpp v8, v40 quad_perm:[0,0,0,0] row_mask:0xf bank_mask:0xf
    v_mov_b32_dpp v9, v42 quad_perm:[2,2,2,2] row_mask:0xf bank_mask:0xf
    s_nop 0
    v_add_f32_dpp v8, v41, v8 quad_perm:[1,1,1,1] row_mask:0xf bank_mask:0xf
    v_add_f32_dpp v9, v43, v9 quad_perm:[3,3,3,3] row_mask:0xf bank_mask:0xf
    v_add_f32 v8, v8, v9
    v_cvt_pk_bf16_f32 v8, v8, v8
    v_lshlrev_b32 v8, 16, v8
    v_mul_f32 v8, 0x3db504f3, v8
    v_cvt_pk_bf16_f32 v8, v8, v8
    v_lshlrev_b32 v8, 16, v8
    v_cmp_gt_f32 vcc, v8, v6
    s_cbranch_vccnz L_resc_b0
L_back_b0:
    v_sub_f32 v9, v8, v6
    v_mul_f32 v9, 0x3fb8aa3b, v9
    v_exp_f32 v9, v9
    s_nop 0
    v_add_f32 v7, v7, v9
    v_cvt_pk_bf16_f32 v9, v9, v9
    v_and_b32 v44, v9, v12
    v_and_b32 v45, v9, v13
    v_and_b32_dpp v46, v9, v14 row_ror:4 row_mask:0xf bank_mask:0xf
    v_and_b32_dpp v47, v9, v15 row_ror:4 row_mask:0xf bank_mask:0xf
    v_and_b32_dpp v48, v9, v12 row_ror:12 row_mask:0xf bank_mask:0xf
    v_and_b32_dpp v49, v9, v13 row_ror:12 row_mask:0xf bank_mask:0xf
    v_and_b32 v50, v9, v14
    v_and_b32 v51, v9, v15
    s_waitcnt vmcnt(13)
    v_mfma_f32_16x16x32_bf16 v[32:35], v[44:47], v[68:71], v[32:35]
    v_mfma_f32_16x16x32_bf16 v[36:39], v[44:47], v[76:79], v[36:39]
    v_mfma_f32_16x16x32_bf16 v[32:35], v[48:51], v[72:75], v[32:35]
    v_mfma_f32_16x16x32_bf16 v[36:39], v[48:51], v[80:83], v[36:39]
    buffer_load_dwordx4 v[68:71], v5, s[44:47], s52 offen offset:0 nt
    s_add_u32 s56, s52, 0x1000
    buffer_load_dwordx4 v[72:75], v5, s[44:47], s56 offen offset:0 nt
    s_add_u32 s56, s52, 0x2000
    buffer_load_dwordx4 v[76:79], v5, s[44:47], s56 offen offset:0 nt
    s_add_u32 s56, s52, 0x3000
    buffer_load_dwordx4 v[80:83], v5, s[44:47], s56 offen offset:0 nt
L_body_b1:
    s_waitcnt vmcnt(12)
    v_mfma_f32_16x16x32_bf16 v[40:43], v[16:19], v[84:87], 0
    v_mfma_f32_16x16x32_bf16 v[40:43], v[20:23], v[88:91], v[40:43]
    v_mfma_f32_16x16x32_bf16 v[40:43], v[24:27], v[92:95], v[40:43]
    v_mfma_f32_16x16x32_bf16 v[40:43], v[28:31], v[96:99], v[40:43]
    s_waitcnt vmcnt(8)
    v_readfirstlane_b32 s48, v148
    s_add_u32 s48, s48, 1856
    s_and_b32 s48, s48, 0xffff
L_chk_b1:
    s_cmp_ge_u32 s48, 2048
    s_cbranch_scc1 L_drain1
L_go_b1:
    s_lshr_b32 s31, s48, 3
    s_and_b32 s31, s31, 0x70
    s_xor_b32 s32, s48, s31
    s_bfe_u32 s31, s32, 0x40000
    s_lshl_b32 s52, s31, 8
    s_bfe_u32 s31, s32, 0x10004
    s_lshl_b32 s31, s31, 21
    s_or_b32 s52, s52, s31
    s_bfe_u32 s31, s32, 0x10005
    s_lshl_b32 s31, s31, 14
    s_or_b32 s52, s52, s31
    s_bfe_u32 s31, s32, 0x40006
    s_lshl_b32 s31, s31, 17
    s_or_b32 s52, s52, s31
    s_bfe_u32 s31, s32, 0x1000a
    s_lshl_b32 s31, s31, 22
    s_or_b32 s52, s52, s31
    s_mov_b64 exec, 1
    global_atomic_add v148, v149, v150, s[26:27] sc0
    s_mov_b64 exec, -1
    buffer_load_dwordx4 v[84:87], v4, s[40:43], s52 offen offset:0 nt
    s_add_u32 s56, s52, 0x8000
    buffer_load_dwordx4 v[88:91], v4, s[40:43], s56 offen offset:0 nt
    s_add_u32 s56, s52, 0x10000
    buffer_load_dwordx4 v[92:95], v4, s[40:43], s56 offen offset:0 nt
    s_add_u32 s56, s52, 0x18000
    buffer_load_dwordx4 v[96:99], v4, s[40:43], s56 offen offset:0 nt
    v_mov_b32_dpp v8, v40 quad_perm:[0,0,0,0] row_mask:0xf bank_mask:0xf
    v_mov_b32_dpp v9, v42 quad_perm:[2,2,2,2] row_mask:0xf bank_mask:0xf
    s_nop 0
    v_add_f32_dpp v8, v41, v8 quad_perm:[1,1,1,1] row_mask:0xf bank_mask:0xf
    v_add_f32_dpp v9, v43, v9 quad_perm:[3,3,3,3] row_mask:0xf bank_mask:0xf
    v_add_f32 v8, v8, v9
    v_cvt_pk_bf16_f32 v8, v8, v8
    v_lshlrev_b32 v8, 16, v8
    v_mul_f32 v8, 0x3db504f3, v8
    v_cvt_pk_bf16_f32 v8, v8, v8
    v_lshlrev_b32 v8, 16, v8
    v_cmp_gt_f32 vcc, v8, v6
    s_cbranch_vccnz L_resc_b1
L_back_b1:
    v_sub_f32 v9, v8, v6
    v_mul_f32 v9, 0x3fb8aa3b, v9
    v_exp_f32 v9, v9
    s_nop 0
    v_add_f32 v7, v7, v9
    v_cvt_pk_bf16_f32 v9, v9, v9
    v_and_b32 v44, v9, v12
    v_and_b32 v45, v9, v13
    v_and_b32_dpp v46, v9, v14 row_ror:4 row_mask:0xf bank_mask:0xf
    v_and_b32_dpp v47, v9, v15 row_ror:4 row_mask:0xf bank_mask:0xf
    v_and_b32_dpp v48, v9, v12 row_ror:12 row_mask:0xf bank_mask:0xf
    v_and_b32_dpp v49, v9, v13 row_ror:12 row_mask:0xf bank_mask:0xf
    v_and_b32 v50, v9, v14
    v_and_b32 v51, v9, v15
    s_waitcnt vmcnt(13)
    v_mfma_f32_16x16x32_bf16 v[32:35], v[44:47], v[100:103], v[32:35]
    v_mfma_f32_16x16x32_bf16 v[36:39], v[44:47], v[108:111], v[36:39]
    v_mfma_f32_16x16x32_bf16 v[32:35], v[48:51], v[104:107], v[32:35]
    v_mfma_f32_16x16x32_bf16 v[36:39], v[48:51], v[112:115], v[36:39]
    buffer_load_dwordx4 v[100:103], v5, s[44:47], s52 offen offset:0 nt
    s_add_u32 s56, s52, 0x1000
    buffer_load_dwordx4 v[104:107], v5, s[44:47], s56 offen offset:0 nt
    s_add_u32 s56, s52, 0x2000
    buffer_load_dwordx4 v[108:111], v5, s[44:47], s56 offen offset:0 nt
    s_add_u32 s56, s52, 0x3000
    buffer_load_dwordx4 v[112:115], v5, s[44:47], s56 offen offset:0 nt
    s_branch L_loopb
L_drain0:
    s_nop 3
    v_mov_b32_dpp v8, v40 quad_perm:[0,0,0,0] row_mask:0xf bank_mask:0xf
    v_mov_b32_dpp v9, v42 quad_perm:[2,2,2,2] row_mask:0xf bank_mask:0xf
    s_nop 0
    v_add_f32_dpp v8, v41, v8 quad_perm:[1,1,1,1] row_mask:0xf bank_mask:0xf
    v_add_f32_dpp v9, v43, v9 quad_perm:[3,3,3,3] row_mask:0xf bank_mask:0xf
    v_add_f32 v8, v8, v9
    v_cvt_pk_bf16_f32 v8, v8, v8
    v_lshlrev_b32 v8, 16, v8
    v_mul_f32 v8, 0x3db504f3, v8
    v_cvt_pk_bf16_f32 v8, v8, v8
    v_lshlrev_b32 v8, 16, v8
    v_cmp_gt_f32 vcc, v8, v6
    s_cbranch_vccnz L_resc_d0
L_back_d0:
    v_sub_f32 v9, v8, v6
    v_mul_f32 v9, 0x3fb8aa3b, v9
    v_exp_f32 v9, v9
    s_nop 0
    v_add_f32 v7, v7, v9
    v_cvt_pk_bf16_f32 v9, v9, v9
    v_and_b32 v44, v9, v12
    v_and_b32 v45, v9, v13
    v_and_b32_dpp v46, v9, v14 row_ror:4 row_mask:0xf bank_mask:0xf
    v_and_b32_dpp v47, v9, v15 row_ror:4 row_mask:0xf bank_mask:0xf
    v_and_b32_dpp v48, v9, v12 row_ror:12 row_mask:0xf bank_mask:0xf
    v_and_b32_dpp v49, v9, v13 row_ror:12 row_mask:0xf bank_mask:0xf
    v_and_b32 v50, v9, v14
    v_and_b32 v51, v9, v15
    s_waitcnt vmcnt(8)
    v_mfma_f32_16x16x32_bf16 v[32:35], v[44:47], v[68:71], v[32:35]
    v_mfma_f32_16x16x32_bf16 v[36:39], v[44:47], v[76:79], v[36:39]
    v_mfma_f32_16x16x32_bf16 v[32:35], v[48:51], v[72:75], v[32:35]
    v_mfma_f32_16x16x32_bf16 v[36:39], v[48:51], v[80:83], v[36:39]
    s_waitcnt vmcnt(4)
    v_mfma_f32_16x16x32_bf16 v[40:43], v[16:19], v[84:87], 0
    v_mfma_f32_16x16x32_bf16 v[40:43], v[20:23], v[88:91], v[40:43]
    v_mfma_f32_16x16x32_bf16 v[40:43], v[24:27], v[92:95], v[40:43]
    v_mfma_f32_16x16x32_bf16 v[40:43], v[28:31], v[96:99], v[40:43]
    s_nop 7
    v_mov_b32_dpp v8, v40 quad_perm:[0,0,0,0] row_mask:0xf bank_mask:0xf
    v_mov_b32_dpp v9, v42 quad_perm:[2,2,2,2] row_mask:0xf bank_mask:0xf
    s_nop 0
    v_add_f32_dpp v8, v41, v8 quad_perm:[1,1,1,1] row_mask:0xf bank_mask:0xf
    v_add_f32_dpp v9, v43, v9 quad_perm:[3,3,3,3] row_mask:0xf bank_mask:0xf
    v_add_f32 v8, v8, v9
    v_cvt_pk_bf16_f32 v8, v8, v8
    v_lshlrev_b32 v8, 16, v8
    v_mul_f32 v8, 0x3db504f3, v8
    v_cvt_pk_bf16_f32 v8, v8, v8
    v_lshlrev_b32 v8, 16, v8
    v_cmp_gt_f32 vcc, v8, v6
    s_cbranch_vccnz L_resc_e0
L_back_e0:
    v_sub_f32 v9, v8, v6
    v_mul_f32 v9, 0x3fb8aa3b, v9
    v_exp_f32 v9, v9
    s_nop 0
    v_add_f32 v7, v7, v9
    v_cvt_pk_bf16_f32 v9, v9, v9
    v_and_b32 v44, v9, v12
    v_and_b32 v45, v9, v13
    v_and_b32_dpp v46, v9, v14 row_ror:4 row_mask:0xf bank_mask:0xf
    v_and_b32_dpp v47, v9, v15 row_ror:4 row_mask:0xf bank_mask:0xf
    v_and_b32_dpp v48, v9, v12 row_ror:12 row_mask:0xf bank_mask:0xf
    v_and_b32_dpp v49, v9, v13 row_ror:12 row_mask:0xf bank_mask:0xf
    v_and_b32 v50, v9, v14
    v_and_b32 v51, v9, v15
    s_waitcnt vmcnt(0)
    v_mfma_f32_16x16x32_bf16 v[32:35], v[44:47], v[100:103], v[32:35]
    v_mfma_f32_16x16x32_bf16 v[36:39], v[44:47], v[108:111], v[36:39]
    v_mfma_f32_16x16x32_bf16 v[32:35], v[48:51], v[104:107], v[32:35]
    v_mfma_f32_16x16x32_bf16 v[36:39], v[48:51], v[112:115], v[36:39]
    s_branch L_exit
L_drain1:
    s_nop 3
    v_mov_b32_dpp v8, v40 quad_perm:[0,0,0,0] row_mask:0xf bank_mask:0xf
    v_mov_b32_dpp v9, v42 quad_perm:[2,2,2,2] row_mask:0xf bank_mask:0xf
    s_nop 0
    v_add_f32_dpp v8, v41, v8 quad_perm:[1,1,1,1] row_mask:0xf bank_mask:0xf
    v_add_f32_dpp v9, v43, v9 quad_perm:[3,3,3,3] row_mask:0xf bank_mask:0xf
    v_add_f32 v8, v8, v9
    v_cvt_pk_bf16_f32 v8, v8, v8
    v_lshlrev_b32 v8, 16, v8
    v_mul_f32 v8, 0x3db504f3, v8
    v_cvt_pk_bf16_f32 v8, v8, v8
    v_lshlrev_b32 v8, 16, v8
    v_cmp_gt_f32 vcc, v8, v6
    s_cbranch_vccnz L_resc_d1
L_back_d1:
    v_sub_f32 v9, v8, v6
    v_mul_f32 v9, 0x3fb8aa3b, v9
    v_exp_f32 v9, v9
    s_nop 0
    v_add_f32 v7, v7, v9
    v_cvt_pk_bf16_f32 v9, v9, v9
    v_and_b32 v44, v9, v12
    v_and_b32 v45, v9, v13
    v_and_b32_dpp v46, v9, v14 row_ror:4 row_mask:0xf bank_mask:0xf
    v_and_b32_dpp v47, v9, v15 row_ror:4 row_mask:0xf bank_mask:0xf
    v_and_b32_dpp v48, v9, v12 row_ror:12 row_mask:0xf bank_mask:0xf
    v_and_b32_dpp v49, v9, v13 row_ror:12 row_mask:0xf bank_mask:0xf
    v_and_b32 v50, v9, v14
    v_and_b32 v51, v9, v15
    s_waitcnt vmcnt(8)
    v_mfma_f32_16x16x32_bf16 v[32:35], v[44:47], v[100:103], v[32:35]
    v_mfma_f32_16x16x32_bf16 v[36:39], v[44:47], v[108:111], v[36:39]
    v_mfma_f32_16x16x32_bf16 v[32:35], v[48:51], v[104:107], v[32:35]
    v_mfma_f32_16x16x32_bf16 v[36:39], v[48:51], v[112:115], v[36:39]
    s_waitcnt vmcnt(4)
    v_mfma_f32_16x16x32_bf16 v[40:43], v[16:19], v[52:55], 0
    v_mfma_f32_16x16x32_bf16 v[40:43], v[20:23], v[56:59], v[40:43]
    v_mfma_f32_16x16x32_bf16 v[40:43], v[24:27], v[60:63], v[40:43]
    v_mfma_f32_16x16x32_bf16 v[40:43], v[28:31], v[64:67], v[40:43]
    s_nop 7
    v_mov_b32_dpp v8, v40 quad_perm:[0,0,0,0] row_mask:0xf bank_mask:0xf
    v_mov_b32_dpp v9, v42 quad_perm:[2,2,2,2] row_mask:0xf bank_mask:0xf
    s_nop 0
    v_add_f32_dpp v8, v41, v8 quad_perm:[1,1,1,1] row_mask:0xf bank_mask:0xf
    v_add_f32_dpp v9, v43, v9 quad_perm:[3,3,3,3] row_mask:0xf bank_mask:0xf
    v_add_f32 v8, v8, v9
    v_cvt_pk_bf16_f32 v8, v8, v8
    v_lshlrev_b32 v8, 16, v8
    v_mul_f32 v8, 0x3db504f3, v8
    v_cvt_pk_bf16_f32 v8, v8, v8
    v_lshlrev_b32 v8, 16, v8
    v_cmp_gt_f32 vcc, v8, v6
    s_cbranch_vccnz L_resc_e1
L_back_e1:
    v_sub_f32 v9, v8, v6
    v_mul_f32 v9, 0x3fb8aa3b, v9
    v_exp_f32 v9, v9
    s_nop 0
    v_add_f32 v7, v7, v9
    v_cvt_pk_bf16_f32 v9, v9, v9
    v_and_b32 v44, v9, v12
    v_and_b32 v45, v9, v13
    v_and_b32_dpp v46, v9, v14 row_ror:4 row_mask:0xf bank_mask:0xf
    v_and_b32_dpp v47, v9, v15 row_ror:4 row_mask:0xf bank_mask:0xf
    v_and_b32_dpp v48, v9, v12 row_ror:12 row_mask:0xf bank_mask:0xf
    v_and_b32_dpp v49, v9, v13 row_ror:12 row_mask:0xf bank_mask:0xf
    v_and_b32 v50, v9, v14
    v_and_b32 v51, v9, v15
    s_waitcnt vmcnt(0)
    v_mfma_f32_16x16x32_bf16 v[32:35], v[44:47], v[68:71], v[32:35]
    v_mfma_f32_16x16x32_bf16 v[36:39], v[44:47], v[76:79], v[36:39]
    v_mfma_f32_16x16x32_bf16 v[32:35], v[48:51], v[72:75], v[32:35]
    v_mfma_f32_16x16x32_bf16 v[36:39], v[48:51], v[80:83], v[36:39]
L_exit:
    s_nop 7
    v_add_f32_dpp v7, v7, v7 row_ror:8 row_mask:0xf bank_mask:0xf
    s_nop 1
    v_add_f32_dpp v7, v7, v7 row_ror:4 row_mask:0xf bank_mask:0xf
    v_mov_b32 v8, v7
    s_nop 1
    v_permlane16_swap_b32 v7, v8
    v_add_f32 v7, v7, v8
    v_mov_b32 v8, v7
    s_nop 1
    v_permlane32_swap_b32 v7, v8
    v_add_f32 v7, v7, v8
    v_permlane32_swap_b32 v36, v44
    v_permlane32_swap_b32 v37, v45
    v_permlane32_swap_b32 v38, v46
    v_permlane32_swap_b32 v39, v47
    v_add_f32 v32, v32, v44
    v_add_f32 v33, v33, v45
    v_add_f32 v34, v34, v46
    v_add_f32 v35, v35, v47
    s_lshl_b32 s31, s28, 10
    v_lshl_add_u32 v8, v10, 1, s31
    v_lshl_add_u32 v9, v1, 4, s31
    ds_write_b64 v9, v[6:7] offset:13576
    s_mov_b32 exec_hi, 0
    ds_write_b64 v8, v[32:33] offset:13568
    ds_write_b64 v8, v[34:35] offset:13584
    s_mov_b64 exec, -1
    s_lshl_b32 s31, s28, 6
    v_lshl_add_u32 v8, v3, 4, s31
    s_waitcnt lgkmcnt(0)
    s_barrier
    global_load_dwordx4 v[116:119], v164, s[12:13] offset:-4096 nt
    global_load_dwordx4 v[120:123], v164, s[12:13] offset:-2048 nt
    global_load_dwordx4 v[124:127], v164, s[12:13] offset:0 nt
    global_load_dwordx4 v[128:131], v164, s[12:13] offset:2048 nt
    s_mov_b32 exec_lo, s34
    s_mov_b32 exec_hi, s34
    global_load_dwordx4 v[132:135], v165, s[20:21] offset:-4096 nt
    global_load_dwordx4 v[136:139], v165, s[20:21] offset:-2048 nt
    global_load_dwordx4 v[140:143], v165, s[20:21] offset:0 nt
    global_load_dwordx4 v[144:147], v165, s[20:21] offset:2048 nt
    s_mov_b64 exec, -1
    ds_read_b128 v[44:47], v8 offset:12544
    s_waitcnt lgkmcnt(0)
    v_and_b32 v16, v44, v12
    v_and_b32 v17, v44, v13
    v_and_b32 v18, v44, v14
    v_and_b32 v19, v44, v15
    v_and_b32 v20, v45, v12
    v_and_b32 v21, v45, v13
    v_and_b32 v22, v45, v14
    v_and_b32 v23, v45, v15
    v_and_b32 v24, v46, v12
    v_and_b32 v25, v46, v13
    v_and_b32 v26, v46, v14
    v_and_b32 v27, v46, v15
    v_and_b32 v28, v47, v12
    v_and_b32 v29, v47, v13
    v_and_b32 v30, v47, v14
    v_and_b32 v31, v47, v15
    s_waitcnt vmcnt(0)
    v_mfma_f32_16x16x32_bf16 v[40:43], v[16:19], v[132:135], 0
    v_mfma_f32_16x16x32_bf16 v[40:43], v[20:23], v[136:139], v[40:43]
    v_mfma_f32_16x16x32_bf16 v[40:43], v[24:27], v[140:143], v[40:43]
    v_mfma_f32_16x16x32_bf16 v[40:43], v[28:31], v[144:147], v[40:43]
    s_nop 7
    ds_write_b128 v11, v[40:43] offset:512
    s_waitcnt lgkmcnt(0)
    s_barrier
    ds_read_b128 v[44:47], v8 offset:13056
    s_waitcnt lgkmcnt(0)
    v_and_b32 v16, v44, v12
    v_and_b32 v17, v44, v13
    v_and_b32 v18, v44, v14
    v_and_b32 v19, v44, v15
    v_and_b32 v20, v45, v12
    v_and_b32 v21, v45, v13
    v_and_b32 v22, v45, v14
    v_and_b32 v23, v45, v15
    v_and_b32 v24, v46, v12
    v_and_b32 v25, v46, v13
    v_and_b32 v26, v46, v14
    v_and_b32 v27, v46, v15
    v_and_b32 v28, v47, v12
    v_and_b32 v29, v47, v13
    v_and_b32 v30, v47, v14
    v_and_b32 v31, v47, v15
    v_mfma_f32_16x16x32_bf16 v[40:43], v[16:19], v[116:119], 0
    v_mfma_f32_16x16x32_bf16 v[40:43], v[20:23], v[120:123], v[40:43]
    v_mfma_f32_16x16x32_bf16 v[40:43], v[24:27], v[124:127], v[40:43]
    v_mfma_f32_16x16x32_bf16 v[40:43], v[28:31], v[128:131], v[40:43]
    s_nop 7
    ds_write_b128 v11, v[40:43] offset:0
    s_waitcnt lgkmcnt(0)
    s_barrier
    s_endpgm
L_resc_u0:
    s_nop 7
    v_max_f32_dpp v9, v8, v8 row_ror:4 row_mask:0xf bank_mask:0xf
    s_nop 1
    v_max_f32_dpp v9, v9, v9 row_ror:8 row_mask:0xf bank_mask:0xf
    v_mov_b32 v44, v9
    s_nop 1
    v_permlane16_swap_b32 v9, v44
    v_max_f32 v9, v9, v44
    v_mov_b32 v44, v9
    s_nop 1
    v_permlane32_swap_b32 v9, v44
    v_max3_f32 v9, v9, v44, v6
    v_sub_f32 v44, v6, v9
    v_mul_f32 v44, 0x3fb8aa3b, v44
    v_exp_f32 v44, v44
    v_mov_b32 v6, v9
    v_mul_f32 v32, v32, v44
    v_mul_f32 v36, v36, v44
    v_mul_f32 v33, v33, v44
    v_mul_f32 v37, v37, v44
    v_mul_f32 v34, v34, v44
    v_mul_f32 v38, v38, v44
    v_mul_f32 v35, v35, v44
    v_mul_f32 v39, v39, v44
    v_mul_f32 v7, v7, v44
    s_branch L_back_u0
L_resc_w0:
    s_nop 7
    v_max_f32_dpp v9, v8, v8 row_ror:4 row_mask:0xf bank_mask:0xf
    s_nop 1
    v_max_f32_dpp v9, v9, v9 row_ror:8 row_mask:0xf bank_mask:0xf
    v_mov_b32 v44, v9
    s_nop 1
    v_permlane16_swap_b32 v9, v44
    v_max_f32 v9, v9, v44
    v_mov_b32 v44, v9
    s_nop 1
    v_permlane32_swap_b32 v9, v44
    v_max3_f32 v9, v9, v44, v6
    v_sub_f32 v44, v6, v9
    v_mul_f32 v44, 0x3fb8aa3b, v44
    v_exp_f32 v44, v44
    v_mov_b32 v6, v9
    v_mul_f32 v32, v32, v44
    v_mul_f32 v36, v36, v44
    v_mul_f32 v33, v33, v44
    v_mul_f32 v37, v37, v44
    v_mul_f32 v34, v34, v44
    v_mul_f32 v38, v38, v44
    v_mul_f32 v35, v35, v44
    v_mul_f32 v39, v39, v44
    v_mul_f32 v7, v7, v44
    s_branch L_back_w0
L_resc_u1:
    s_nop 7
    v_max_f32_dpp v9, v8, v8 row_ror:4 row_mask:0xf bank_mask:0xf
    s_nop 1
    v_max_f32_dpp v9, v9, v9 row_ror:8 row_mask:0xf bank_mask:0xf
    v_mov_b32 v44, v9
    s_nop 1
    v_permlane16_swap_b32 v9, v44
    v_max_f32 v9, v9, v44
    v_mov_b32 v44, v9
    s_nop 1
    v_permlane32_swap_b32 v9, v44
    v_max3_f32 v9, v9, v44, v6
    v_sub_f32 v44, v6, v9
    v_mul_f32 v44, 0x3fb8aa3b, v44
    v_exp_f32 v44, v44
    v_mov_b32 v6, v9
    v_mul_f32 v32, v32, v44
    v_mul_f32 v36, v36, v44
    v_mul_f32 v33, v33, v44
    v_mul_f32 v37, v37, v44
    v_mul_f32 v34, v34, v44
    v_mul_f32 v38, v38, v44
    v_mul_f32 v35, v35, v44
    v_mul_f32 v39, v39, v44
    v_mul_f32 v7, v7, v44
    s_branch L_back_u1
L_resc_w1:
    s_nop 7
    v_max_f32_dpp v9, v8, v8 row_ror:4 row_mask:0xf bank_mask:0xf
    s_nop 1
    v_max_f32_dpp v9, v9, v9 row_ror:8 row_mask:0xf bank_mask:0xf
    v_mov_b32 v44, v9
    s_nop 1
    v_permlane16_swap_b32 v9, v44
    v_max_f32 v9, v9, v44
    v_mov_b32 v44, v9
    s_nop 1
    v_permlane32_swap_b32 v9, v44
    v_max3_f32 v9, v9, v44, v6
    v_sub_f32 v44, v6, v9
    v_mul_f32 v44, 0x3fb8aa3b, v44
    v_exp_f32 v44, v44
    v_mov_b32 v6, v9
    v_mul_f32 v32, v32, v44
    v_mul_f32 v36, v36, v44
    v_mul_f32 v33, v33, v44
    v_mul_f32 v37, v37, v44
    v_mul_f32 v34, v34, v44
    v_mul_f32 v38, v38, v44
    v_mul_f32 v35, v35, v44
    v_mul_f32 v39, v39, v44
    v_mul_f32 v7, v7, v44
    s_branch L_back_w1
L_resc_z0:
    s_nop 7
    v_max_f32_dpp v9, v8, v8 row_ror:4 row_mask:0xf bank_mask:0xf
    s_nop 1
    v_max_f32_dpp v9, v9, v9 row_ror:8 row_mask:0xf bank_mask:0xf
    v_mov_b32 v44, v9
    s_nop 1
    v_permlane16_swap_b32 v9, v44
    v_max_f32 v9, v9, v44
    v_mov_b32 v44, v9
    s_nop 1
    v_permlane32_swap_b32 v9, v44
    v_max3_f32 v9, v9, v44, v6
    v_sub_f32 v44, v6, v9
    v_mul_f32 v44, 0x3fb8aa3b, v44
    v_exp_f32 v44, v44
    v_mov_b32 v6, v9
    v_mul_f32 v32, v32, v44
    v_mul_f32 v36, v36, v44
    v_mul_f32 v33, v33, v44
    v_mul_f32 v37, v37, v44
    v_mul_f32 v34, v34, v44
    v_mul_f32 v38, v38, v44
    v_mul_f32 v35, v35, v44
    v_mul_f32 v39, v39, v44
    v_mul_f32 v7, v7, v44
    s_branch L_back_z0
L_resc_z1:
    s_nop 7
    v_max_f32_dpp v9, v8, v8 row_ror:4 row_mask:0xf bank_mask:0xf
    s_nop 1
    v_max_f32_dpp v9, v9, v9 row_ror:8 row_mask:0xf bank_mask:0xf
    v_mov_b32 v44, v9
    s_nop 1
    v_permlane16_swap_b32 v9, v44
    v_max_f32 v9, v9, v44
    v_mov_b32 v44, v9
    s_nop 1
    v_permlane32_swap_b32 v9, v44
    v_max3_f32 v9, v9, v44, v6
    v_sub_f32 v44, v6, v9
    v_mul_f32 v44, 0x3fb8aa3b, v44
    v_exp_f32 v44, v44
    v_mov_b32 v6, v9
    v_mul_f32 v32, v32, v44
    v_mul_f32 v36, v36, v44
    v_mul_f32 v33, v33, v44
    v_mul_f32 v37, v37, v44
    v_mul_f32 v34, v34, v44
    v_mul_f32 v38, v38, v44
    v_mul_f32 v35, v35, v44
    v_mul_f32 v39, v39, v44
    v_mul_f32 v7, v7, v44
    s_branch L_back_z1
L_resc_a0:
    s_nop 7
    v_max_f32_dpp v9, v8, v8 row_ror:4 row_mask:0xf bank_mask:0xf
    s_nop 1
    v_max_f32_dpp v9, v9, v9 row_ror:8 row_mask:0xf bank_mask:0xf
    v_mov_b32 v44, v9
    s_nop 1
    v_permlane16_swap_b32 v9, v44
    v_max_f32 v9, v9, v44
    v_mov_b32 v44, v9
    s_nop 1
    v_permlane32_swap_b32 v9, v44
    v_max3_f32 v9, v9, v44, v6
    v_sub_f32 v44, v6, v9
    v_mul_f32 v44, 0x3fb8aa3b, v44
    v_exp_f32 v44, v44
    v_mov_b32 v6, v9
    v_mul_f32 v32, v32, v44
    v_mul_f32 v36, v36, v44
    v_mul_f32 v33, v33, v44
    v_mul_f32 v37, v37, v44
    v_mul_f32 v34, v34, v44
    v_mul_f32 v38, v38, v44
    v_mul_f32 v35, v35, v44
    v_mul_f32 v39, v39, v44
    v_mul_f32 v7, v7, v44
    s_branch L_back_a0
L_resc_a1:
    s_nop 7
    v_max_f32_dpp v9, v8, v8 row_ror:4 row_mask:0xf bank_mask:0xf
    s_nop 1
    v_max_f32_dpp v9, v9, v9 row_ror:8 row_mask:0xf bank_mask:0xf
    v_mov_b32 v44, v9
    s_nop 1
    v_permlane16_swap_b32 v9, v44
    v_max_f32 v9, v9, v44
    v_mov_b32 v44, v9
    s_nop 1
    v_permlane32_swap_b32 v9, v44
    v_max3_f32 v9, v9, v44, v6
    v_sub_f32 v44, v6, v9
    v_mul_f32 v44, 0x3fb8aa3b, v44
    v_exp_f32 v44, v44
    v_mov_b32 v6, v9
    v_mul_f32 v32, v32, v44
    v_mul_f32 v36, v36, v44
    v_mul_f32 v33, v33, v44
    v_mul_f32 v37, v37, v44
    v_mul_f32 v34, v34, v44
    v_mul_f32 v38, v38, v44
    v_mul_f32 v35, v35, v44
    v_mul_f32 v39, v39, v44
    v_mul_f32 v7, v7, v44
    s_branch L_back_a1
L_resc_b0:
    s_nop 7
    v_max_f32_dpp v9, v8, v8 row_ror:4 row_mask:0xf bank_mask:0xf
    s_nop 1
    v_max_f32_dpp v9, v9, v9 row_ror:8 row_mask:0xf bank_mask:0xf
    v_mov_b32 v44, v9
    s_nop 1
    v_permlane16_swap_b32 v9, v44
    v_max_f32 v9, v9, v44
    v_mov_b32 v44, v9
    s_nop 1
    v_permlane32_swap_b32 v9, v44
    v_max3_f32 v9, v9, v44, v6
    v_sub_f32 v44, v6, v9
    v_mul_f32 v44, 0x3fb8aa3b, v44
    v_exp_f32 v44, v44
    v_mov_b32 v6, v9
    v_mul_f32 v32, v32, v44
    v_mul_f32 v36, v36, v44
    v_mul_f32 v33, v33, v44
    v_mul_f32 v37, v37, v44
    v_mul_f32 v34, v34, v44
    v_mul_f32 v38, v38, v44
    v_mul_f32 v35, v35, v44
    v_mul_f32 v39, v39, v44
    v_mul_f32 v7, v7, v44
    s_branch L_back_b0
L_resc_b1:
    s_nop 7
    v_max_f32_dpp v9, v8, v8 row_ror:4 row_mask:0xf bank_mask:0xf
    s_nop 1
    v_max_f32_dpp v9, v9, v9 row_ror:8 row_mask:0xf bank_mask:0xf
    v_mov_b32 v44, v9
    s_nop 1
    v_permlane16_swap_b32 v9, v44
    v_max_f32 v9, v9, v44
    v_mov_b32 v44, v9
    s_nop 1
    v_permlane32_swap_b32 v9, v44
    v_max3_f32 v9, v9, v44, v6
    v_sub_f32 v44, v6, v9
    v_mul_f32 v44, 0x3fb8aa3b, v44
    v_exp_f32 v44, v44
    v_mov_b32 v6, v9
    v_mul_f32 v32, v32, v44
    v_mul_f32 v36, v36, v44
    v_mul_f32 v33, v33, v44
    v_mul_f32 v37, v37, v44
    v_mul_f32 v34, v34, v44
    v_mul_f32 v38, v38, v44
    v_mul_f32 v35, v35, v44
    v_mul_f32 v39, v39, v44
    v_mul_f32 v7, v7, v44
    s_branch L_back_b1
L_resc_d0:
    s_nop 7
    v_max_f32_dpp v9, v8, v8 row_ror:4 row_mask:0xf bank_mask:0xf
    s_nop 1
    v_max_f32_dpp v9, v9, v9 row_ror:8 row_mask:0xf bank_mask:0xf
    v_mov_b32 v44, v9
    s_nop 1
    v_permlane16_swap_b32 v9, v44
    v_max_f32 v9, v9, v44
    v_mov_b32 v44, v9
    s_nop 1
    v_permlane32_swap_b32 v9, v44
    v_max3_f32 v9, v9, v44, v6
    v_sub_f32 v44, v6, v9
    v_mul_f32 v44, 0x3fb8aa3b, v44
    v_exp_f32 v44, v44
    v_mov_b32 v6, v9
    v_mul_f32 v32, v32, v44
    v_mul_f32 v36, v36, v44
    v_mul_f32 v33, v33, v44
    v_mul_f32 v37, v37, v44
    v_mul_f32 v34, v34, v44
    v_mul_f32 v38, v38, v44
    v_mul_f32 v35, v35, v44
    v_mul_f32 v39, v39, v44
    v_mul_f32 v7, v7, v44
    s_branch L_back_d0
L_resc_e0:
    s_nop 7
    v_max_f32_dpp v9, v8, v8 row_ror:4 row_mask:0xf bank_mask:0xf
    s_nop 1
    v_max_f32_dpp v9, v9, v9 row_ror:8 row_mask:0xf bank_mask:0xf
    v_mov_b32 v44, v9
    s_nop 1
    v_permlane16_swap_b32 v9, v44
    v_max_f32 v9, v9, v44
    v_mov_b32 v44, v9
    s_nop 1
    v_permlane32_swap_b32 v9, v44
    v_max3_f32 v9, v9, v44, v6
    v_sub_f32 v44, v6, v9
    v_mul_f32 v44, 0x3fb8aa3b, v44
    v_exp_f32 v44, v44
    v_mov_b32 v6, v9
    v_mul_f32 v32, v32, v44
    v_mul_f32 v36, v36, v44
    v_mul_f32 v33, v33, v44
    v_mul_f32 v37, v37, v44
    v_mul_f32 v34, v34, v44
    v_mul_f32 v38, v38, v44
    v_mul_f32 v35, v35, v44
    v_mul_f32 v39, v39, v44
    v_mul_f32 v7, v7, v44
    s_branch L_back_e0
L_resc_d1:
    s_nop 7
    v_max_f32_dpp v9, v8, v8 row_ror:4 row_mask:0xf bank_mask:0xf
    s_nop 1
    v_max_f32_dpp v9, v9, v9 row_ror:8 row_mask:0xf bank_mask:0xf
    v_mov_b32 v44, v9
    s_nop 1
    v_permlane16_swap_b32 v9, v44
    v_max_f32 v9, v9, v44
    v_mov_b32 v44, v9
    s_nop 1
    v_permlane32_swap_b32 v9, v44
    v_max3_f32 v9, v9, v44, v6
    v_sub_f32 v44, v6, v9
    v_mul_f32 v44, 0x3fb8aa3b, v44
    v_exp_f32 v44, v44
    v_mov_b32 v6, v9
    v_mul_f32 v32, v32, v44
    v_mul_f32 v36, v36, v44
    v_mul_f32 v33, v33, v44
    v_mul_f32 v37, v37, v44
    v_mul_f32 v34, v34, v44
    v_mul_f32 v38, v38, v44
    v_mul_f32 v35, v35, v44
    v_mul_f32 v39, v39, v44
    v_mul_f32 v7, v7, v44
    s_branch L_back_d1
L_resc_e1:
    s_nop 7
    v_max_f32_dpp v9, v8, v8 row_ror:4 row_mask:0xf bank_mask:0xf
    s_nop 1
    v_max_f32_dpp v9, v9, v9 row_ror:8 row_mask:0xf bank_mask:0xf
    v_mov_b32 v44, v9
    s_nop 1
    v_permlane16_swap_b32 v9, v44
    v_max_f32 v9, v9, v44
    v_mov_b32 v44, v9
    s_nop 1
    v_permlane32_swap_b32 v9, v44
    v_max3_f32 v9, v9, v44, v6
    v_sub_f32 v44, v6, v9
    v_mul_f32 v44, 0x3fb8aa3b, v44
    v_exp_f32 v44, v44
    v_mov_b32 v6, v9
    v_mul_f32 v32, v32, v44
    v_mul_f32 v36, v36, v44
    v_mul_f32 v33, v33, v44
    v_mul_f32 v37, v37, v44
    v_mul_f32 v34, v34, v44
    v_mul_f32 v38, v38, v44
    v_mul_f32 v35, v35, v44
    v_mul_f32 v39, v39, v44
    v_mul_f32 v7, v7, v44
    s_branch L_back_e1
L_service:
    s_setprio 3
    v_lshlrev_b32 v4, 4, v1
    v_lshlrev_b32 v5, 3, v1
    s_mov_b32 s36, 1048576
    s_lshl_b32 s31, s2, 10
    v_add_u32 v6, s31, v4
    s_mul_i32 s31, s29, 4352
    s_lshl_b32 s32, s30, 9
    s_add_u32 s31, s31, s32
    s_add_u32 s31, s31, 0x280000
    v_and_b32 v12, 31, v1
    v_lshlrev_b32 v12, 4, v12
    v_lshrrev_b32 v13, 5, v1
    s_sub_u32 s32, s3, s29
    s_add_u32 s32, s32, 32
    s_mul_i32 s32, s32, 4352
    v_mul_u32_u24 v13, s32, v13
    v_add3_u32 v7, v13, v12, s31
    v_mov_b32 v16, -1
    v_mov_b32 v17, -1
    v_mov_b32 v18, -1
    v_mov_b32 v19, -1
    s_cmp_lt_u32 s3, 28
    s_cselect_b32 s32, 64, 32
    v_cmp_gt_u32 vcc, s32, v1
    s_nop 1
    v_cndmask_b32 v20, 0, -1, vcc
    v_mov_b32 v21, v20
    v_mov_b32 v22, v20
    v_mov_b32 v23, v20
    s_lshl_b32 s31, s3, 3
    s_add_u32 s31, s31, s30
    s_lshl_b32 s31, s31, 10
    s_add_u32 s31, s31, 0x40000
    v_add_u32 v14, s31, v4
    v_add_u32 v6, 0x80000, v6
    v_add_u32 v15, 0x180000, v6
    s_waitcnt lgkmcnt(0)
    s_add_u32 s42, s26, 0x1fff00
    s_addc_u32 s43, s27, 0
    s_load_dword s40, s[42:43], 0
    s_load_dword s41, s[42:43], 0x40100
    global_store_dwordx4 v6, v[16:19], s[26:27] sc1
    global_store_dwordx4 v14, v[16:19], s[26:27] sc1
    global_store_dwordx4 v7, v[20:23], s[26:27] sc1
    s_lshl_b32 s31, s29, 8
    s_add_u32 s31, s31, 0x400000
    v_mov_b32 v12, s31
    v_mov_b32 v13, 0
    s_mov_b64 exec, 1
    global_store_dword v12, v13, s[26:27] sc1
    v_add_u32 v12, 0x2000, v12
    global_store_dword v12, v13, s[26:27] sc1
    s_mov_b64 exec, -1
    s_lshl_b32 s31, s29, 13
    s_add_u32 s31, s31, 0x201000
    v_add_u32 v8, s31, v4
    v_mov_b32 v10, 0
    v_mov_b32 v9, 0
    v_lshlrev_b32 v13, 2, v1
    s_waitcnt lgkmcnt(0)
    s_mul_i32 s40, s40, 0x9e3779b1
    s_add_u32 s40, s40, 0x7f4a7c15
    s_mul_i32 s41, s41, 0x2c1b3c6d
    s_add_u32 s41, s41, 0x297a2d39
    v_mov_b32 v17, s40
    v_mov_b32 v19, s41
    s_waitcnt vmcnt(0)
    s_barrier
    ds_read_b64 v[32:33], v5 offset:0
    ds_read_b64 v[34:35], v5 offset:1536
    ds_read_b64 v[36:37], v5 offset:3072
    ds_read_b64 v[38:39], v5 offset:4608
    ds_read_b64 v[40:41], v5 offset:6144
    ds_read_b64 v[42:43], v5 offset:7680
    ds_read_b64 v[44:45], v5 offset:9216
    ds_read_b64 v[46:47], v5 offset:10752
    s_waitcnt lgkmcnt(6)
    v_add_f32 v16, v32, v34
    v_add_f32 v18, v33, v35
    s_waitcnt lgkmcnt(5)
    v_add_f32 v16, v16, v36
    v_add_f32 v18, v18, v37
    s_waitcnt lgkmcnt(4)
    v_add_f32 v16, v16, v38
    v_add_f32 v18, v18, v39
    s_waitcnt lgkmcnt(3)
    v_add_f32 v16, v16, v40
    v_add_f32 v18, v18, v41
    s_waitcnt lgkmcnt(2)
    v_add_f32 v16, v16, v42
    v_add_f32 v18, v18, v43
    s_waitcnt lgkmcnt(1)
    v_add_f32 v16, v16, v44
    v_add_f32 v18, v18, v45
    s_waitcnt lgkmcnt(0)
    v_add_f32 v16, v16, v46
    v_add_f32 v18, v18, v47
    global_store_dwordx4 v15, v[16:19], s[26:27] sc1
L_poll1:
    global_load_dwordx4 v[32:35], v8, s[26:27] offset:-4096 sc1
    global_load_dwordx4 v[36:39], v8, s[26:27] offset:-3072 sc1
    global_load_dwordx4 v[40:43], v8, s[26:27] offset:-2048 sc1
    global_load_dwordx4 v[44:47], v8, s[26:27] offset:-1024 sc1
    global_load_dwordx4 v[48:51], v8, s[26:27] offset:0 sc1
    global_load_dwordx4 v[52:55], v8, s[26:27] offset:1024 sc1
    global_load_dwordx4 v[56:59], v8, s[26:27] offset:2048 sc1
    global_load_dwordx4 v[60:63], v8, s[26:27] offset:3072 sc1
    s_sub_u32 s36, s36, 1
    s_cmp_eq_u32 s36, 0
    s_cbranch_scc1 L_svc_end
    s_waitcnt vmcnt(0)
    v_max3_u32 v12, v33, v37, s40
    v_min3_u32 v15, v33, v37, s40
    v_max3_u32 v12, v12, v41, v45
    v_min3_u32 v15, v15, v41, v45
    v_max3_u32 v12, v12, v49, v53
    v_min3_u32 v15, v15, v49, v53
    v_max3_u32 v12, v12, v57, v61
    v_min3_u32 v15, v15, v57, v61
    v_max3_u32 v20, v35, v39, s41
    v_min3_u32 v21, v35, v39, s41
    v_max3_u32 v20, v20, v43, v47
    v_min3_u32 v21, v21, v43, v47
    v_max3_u32 v20, v20, v51, v55
    v_min3_u32 v21, v21, v51, v55
    v_max3_u32 v20, v20, v59, v63
    v_min3_u32 v21, v21, v59, v63
    v_xor_b32 v12, v12, v15
    v_xor_b32 v15, v20, v21
    v_or_b32 v12, v12, v15
    v_cmp_ne_u32 vcc, 0, v12
    s_cbranch_vccnz L_poll1
    v_add_f32 v16, v32, v36
    v_add_f32 v17, v34, v38
    v_add_f32 v16, v16, v40
    v_add_f32 v17, v17, v42
    v_add_f32 v16, v16, v44
    v_add_f32 v17, v17, v46
    v_add_f32 v16, v16, v48
    v_add_f32 v17, v17, v50
    v_add_f32 v16, v16, v52
    v_add_f32 v17, v17, v54
    v_add_f32 v16, v16, v56
    v_add_f32 v17, v17, v58
    v_add_f32 v16, v16, v60
    v_add_f32 v17, v17, v62
    v_cvt_pk_bf16_f32 v12, v16, v17
    ds_write_b32 v13, v12 offset:12288
    s_waitcnt lgkmcnt(0)
    s_barrier
    s_cmp_ge_u32 s3, 28
    s_cbranch_scc1 L_noffn
    ds_read_b128 v[32:35], v4 offset:512
    ds_read_b128 v[36:39], v4 offset:2048
    ds_read_b128 v[40:43], v4 offset:3584
    ds_read_b128 v[44:47], v4 offset:5120
    ds_read_b128 v[48:51], v4 offset:6656
    ds_read_b128 v[52:55], v4 offset:8192
    ds_read_b128 v[56:59], v4 offset:9728
    ds_read_b128 v[60:63], v4 offset:11264
    s_waitcnt lgkmcnt(6)
    v_add_f32 v16, v32, v36
    v_add_f32 v17, v33, v37
    v_add_f32 v18, v34, v38
    v_add_f32 v19, v35, v39
    s_waitcnt lgkmcnt(5)
    v_add_f32 v16, v16, v40
    v_add_f32 v17, v17, v41
    v_add_f32 v18, v18, v42
    v_add_f32 v19, v19, v43
    s_waitcnt lgkmcnt(4)
    v_add_f32 v16, v16, v44
    v_add_f32 v17, v17, v45
    v_add_f32 v18, v18, v46
    v_add_f32 v19, v19, v47
    s_waitcnt lgkmcnt(3)
    v_add_f32 v16, v16, v48
    v_add_f32 v17, v17, v49
    v_add_f32 v18, v18, v50
    v_add_f32 v19, v19, v51
    s_waitcnt lgkmcnt(2)
    v_add_f32 v16, v16, v52
    v_add_f32 v17, v17, v53
    v_add_f32 v18, v18, v54
    v_add_f32 v19, v19, v55
    s_waitcnt lgkmcnt(1)
    v_add_f32 v16, v16, v56
    v_add_f32 v17, v17, v57
    v_add_f32 v18, v18, v58
    v_add_f32 v19, v19, v59
    s_waitcnt lgkmcnt(0)
    v_add_f32 v16, v16, v60
    v_add_f32 v17, v17, v61
    v_add_f32 v18, v18, v62
    v_add_f32 v19, v19, v63
    v_min_u32 v16, -2, v16
    v_min_u32 v17, -2, v17
    v_min_u32 v18, -2, v18
    v_min_u32 v19, -2, v19
    global_store_dwordx4 v14, v[16:19], s[26:27] sc1
    v_and_b32 v13, 7, v1
    v_mul_u32_u24 v14, 5, v13
    v_sub_u32 v14, s3, v14
    v_and_b32 v14, 31, v14
    v_lshl_add_u32 v14, v14, 3, v13
    v_lshlrev_b32 v14, 10, v14
    v_add_u32 v14, 0x200004, v14
L_pollf:
    global_load_dword v12, v14, s[26:27] sc1
    global_load_dword v15, v14, s[26:27] offset:8 sc1
    s_sub_u32 s36, s36, 1
    s_cmp_eq_u32 s36, 0
    s_cbranch_scc1 L_svc_end
    s_waitcnt vmcnt(0)
    v_xor_b32 v12, s40, v12
    v_xor_b32 v15, s41, v15
    v_or_b32 v12, v12, v15
    v_cmp_ne_u32 vcc, 0, v12
    s_cbranch_vccz L_gotf
    s_sleep 8
    s_branch L_pollf
L_gotf:
    s_lshl_b32 s31, s3, 13
    s_add_u32 s31, s31, 0x41000
    v_add_u32 v8, s31, v5
L_poll1b:
    global_load_dwordx2 v[32:33], v8, s[26:27] offset:-4096 sc1
    global_load_dwordx2 v[34:35], v8, s[26:27] offset:-3584 sc1
    global_load_dwordx2 v[36:37], v8, s[26:27] offset:-3072 sc1
    global_load_dwordx2 v[38:39], v8, s[26:27] offset:-2560 sc1
    global_load_dwordx2 v[40:41], v8, s[26:27] offset:-2048 sc1
    global_load_dwordx2 v[42:43], v8, s[26:27] offset:-1536 sc1
    global_load_dwordx2 v[44:45], v8, s[26:27] offset:-1024 sc1
    global_load_dwordx2 v[46:47], v8, s[26:27] offset:-512 sc1
    global_load_dwordx2 v[48:49], v8, s[26:27] offset:0 sc1
    global_load_dwordx2 v[50:51], v8, s[26:27] offset:512 sc1
    global_load_dwordx2 v[52:53], v8, s[26:27] offset:1024 sc1
    global_load_dwordx2 v[54:55], v8, s[26:27] offset:1536 sc1
    global_load_dwordx2 v[56:57], v8, s[26:27] offset:2048 sc1
    global_load_dwordx2 v[58:59], v8, s[26:27] offset:2560 sc1
    global_load_dwordx2 v[60:61], v8, s[26:27] offset:3072 sc1
    global_load_dwordx2 v[62:63], v8, s[26:27] offset:3584 sc1
    s_sub_u32 s36, s36, 1
    s_cmp_eq_u32 s36, 0
    s_cbranch_scc1 L_svc_end
    s_waitcnt vmcnt(0)
    v_max3_u32 v12, v32, v33, v34
    v_max3_u32 v12, v12, v35, v36
    v_max3_u32 v12, v12, v37, v38
    v_max3_u32 v12, v12, v39, v40
    v_max3_u32 v12, v12, v41, v42
    v_max3_u32 v12, v12, v43, v44
    v_max3_u32 v12, v12, v45, v46
    v_max3_u32 v12, v12, v47, v48
    v_max3_u32 v12, v12, v49, v50
    v_max3_u32 v12, v12, v51, v52
    v_max3_u32 v12, v12, v53, v54
    v_max3_u32 v12, v12, v55, v56
    v_max3_u32 v12, v12, v57, v58
    v_max3_u32 v12, v12, v59, v60
    v_max3_u32 v12, v12, v61, v62
    v_max_u32 v12, v12, v63
    v_cmp_eq_u32 vcc, -1, v12
    s_cbranch_vccz L_got1b
    s_sleep 8
    s_branch L_poll1b
L_got1b:
    v_add_f32 v16, v32, v36
    v_add_f32 v17, v33, v37
    v_add_f32 v18, v34, v38
    v_add_f32 v19, v35, v39
    v_add_f32 v16, v16, v40
    v_add_f32 v17, v17, v41
    v_add_f32 v18, v18, v42
    v_add_f32 v19, v19, v43
    v_add_f32 v16, v16, v44
    v_add_f32 v17, v17, v45
    v_add_f32 v18, v18, v46
    v_add_f32 v19, v19, v47
    v_add_f32 v16, v16, v48
    v_add_f32 v17, v17, v49
    v_add_f32 v18, v18, v50
    v_add_f32 v19, v19, v51
    v_add_f32 v16, v16, v52
    v_add_f32 v17, v17, v53
    v_add_f32 v18, v18, v54
    v_add_f32 v19, v19, v55
    v_add_f32 v16, v16, v56
    v_add_f32 v17, v17, v57
    v_add_f32 v18, v18, v58
    v_add_f32 v19, v19, v59
    v_add_f32 v16, v16, v60
    v_add_f32 v17, v17, v61
    v_add_f32 v18, v18, v62
    v_add_f32 v19, v19, v63
    v_cvt_pk_bf16_f32 v16, v16, v16
    v_lshlrev_b32 v16, 16, v16
    v_cvt_pk_bf16_f32 v17, v17, v17
    v_lshlrev_b32 v17, 16, v17
    v_cvt_pk_bf16_f32 v18, v18, v18
    v_lshlrev_b32 v18, 16, v18
    v_cvt_pk_bf16_f32 v19, v19, v19
    v_lshlrev_b32 v19, 16, v19
    v_mul_f32 v12, v16, v16
    v_mul_f32 v12, 0x3d372713, v12
    v_fma_f32 v12, v12, v16, v16
    v_mul_f32 v12, 0xc0135761, v12
    v_exp_f32 v12, v12
    s_nop 0
    v_add_f32 v12, 1.0, v12
    v_rcp_f32 v12, v12
    s_nop 0
    v_mul_f32 v12, v12, v16
    v_cvt_pk_bf16_f32 v12, v12, v12
    v_lshlrev_b32 v12, 16, v12
    v_mul_f32 v12, v12, v18
    v_cvt_pk_bf16_f32 v12, v12, v12
    v_mul_f32 v13, v17, v17
    v_mul_f32 v13, 0x3d372713, v13
    v_fma_f32 v13, v13, v17, v17
    v_mul_f32 v13, 0xc0135761, v13
    v_exp_f32 v13, v13
    s_nop 0
    v_add_f32 v13, 1.0, v13
    v_rcp_f32 v13, v13
    s_nop 0
    v_mul_f32 v13, v13, v17
    v_cvt_pk_bf16_f32 v13, v13, v13
    v_lshlrev_b32 v13, 16, v13
    v_mul_f32 v13, v13, v19
    v_cvt_pk_bf16_f32 v13, v13, v13
    ds_write_b64 v5, v[12:13] offset:12544
L_noffn:
    s_cmp_ge_u32 s29, 4
    s_cbranch_scc1 L_nored1
    s_lshl_b32 s31, s30, 10
    s_add_u32 s31, s31, 0x200004
    v_and_b32 v14, 31, v1
    v_lshlrev_b32 v14, 13, v14
    v_add_u32 v14, s31, v14
L_pollc:
    global_load_dword v12, v14, s[26:27] sc1
    global_load_dword v15, v14, s[26:27] offset:8 sc1
    s_sub_u32 s36, s36, 1
    s_cmp_eq_u32 s36, 0
    s_cbranch_scc1 L_svc_end
    s_waitcnt vmcnt(0)
    v_xor_b32 v12, s40, v12
    v_xor_b32 v15, s41, v15
    v_or_b32 v12, v12, v15
    v_cmp_ne_u32 vcc, 0, v12
    s_cbranch_vccz L_gotc
    s_sleep 32
    s_branch L_pollc
L_gotc:
    s_lshl_b32 s31, s30, 7
    s_lshl_b32 s32, s29, 5
    s_add_u32 s31, s31, s32
    v_and_b32 v12, 7, v1
    v_lshrrev_b32 v13, 3, v1
    v_mul_u32_u24 v10, 0x1100, v13
    v_lshl_add_u32 v10, v12, 4, v10
    s_lshl_b32 s32, s31, 2
    s_add_u32 s32, s32, 0x280000
    v_add_u32 v10, s32, v10
    v_and_b32 v13, 1, v3
    v_lshl_add_u32 v12, v12, 2, v13
    v_add_u32 v12, s31, v12
    v_lshlrev_b32 v9, 1, v12
    global_load_ushort v24, v9, s[4:5]
    global_load_ushort v25, v9, s[4:5] offset:4
L_nored1:
    v_add_u32 v65, 0x8800, v10
    v_add_u32 v66, 0x11000, v10
    v_add_u32 v67, 0x19800, v10
    v_add_u32 v68, 0x22000, v10
    v_add_u32 v69, 0x2a800, v10
    v_add_u32 v70, 0x33000, v10
    v_add_u32 v71, 0x3b800, v10
    s_lshl_b32 s31, s29, 13
    s_add_u32 s31, s31, 0x81000
    v_add_u32 v8, s31, v4
    s_waitcnt vmcnt(0) lgkmcnt(0)
    s_barrier
    ds_read_b128 v[32:35], v4 offset:13568
    ds_read_b128 v[36:39], v4 offset:14592
    ds_read_b128 v[40:43], v4 offset:15616
    ds_read_b128 v[44:47], v4 offset:16640
    ds_read_b128 v[48:51], v4 offset:17664
    ds_read_b128 v[52:55], v4 offset:18688
    ds_read_b128 v[56:59], v4 offset:19712
    ds_read_b128 v[60:63], v4 offset:20736
    s_waitcnt lgkmcnt(0)
    v_max3_f32 v18, v34, v38, v42
    v_max3_f32 v12, v46, v50, v54
    v_max3_f32 v18, v18, v58, v62
    v_max_f32 v18, v18, v12
    v_sub_f32 v34, v34, v18
    v_sub_f32 v38, v38, v18
    v_sub_f32 v42, v42, v18
    v_sub_f32 v46, v46, v18
    v_sub_f32 v50, v50, v18
    v_sub_f32 v54, v54, v18
    v_sub_f32 v58, v58, v18
    v_sub_f32 v62, v62, v18
    v_mul_f32 v34, 0x3fb8aa3b, v34
    v_mul_f32 v38, 0x3fb8aa3b, v38
    v_mul_f32 v42, 0x3fb8aa3b, v42
    v_mul_f32 v46, 0x3fb8aa3b, v46
    v_mul_f32 v50, 0x3fb8aa3b, v50
    v_mul_f32 v54, 0x3fb8aa3b, v54
    v_mul_f32 v58, 0x3fb8aa3b, v58
    v_mul_f32 v62, 0x3fb8aa3b, v62
    v_exp_f32 v34, v34
    v_exp_f32 v38, v38
    v_exp_f32 v42, v42
    v_exp_f32 v46, v46
    v_exp_f32 v50, v50
    v_exp_f32 v54, v54
    v_exp_f32 v58, v58
    v_exp_f32 v62, v62
    v_mul_f32 v16, v34, v32
    v_mul_f32 v17, v34, v33
    v_mul_f32 v19, v34, v35
    v_fmac_f32 v16, v38, v36
    v_fmac_f32 v17, v38, v37
    v_fmac_f32 v19, v38, v39
    v_fmac_f32 v16, v42, v40
    v_fmac_f32 v17, v42, v41
    v_fmac_f32 v19, v42, v43
    v_fmac_f32 v16, v46, v44
    v_fmac_f32 v17, v46, v45
    v_fmac_f32 v19, v46, v47
    v_fmac_f32 v16, v50, v48
    v_fmac_f32 v17, v50, v49
    v_fmac_f32 v19, v50, v51
    v_fmac_f32 v16, v54, v52
    v_fmac_f32 v17, v54, v53
    v_fmac_f32 v19, v54, v55
    v_fmac_f32 v16, v58, v56
    v_fmac_f32 v17, v58, v57
    v_fmac_f32 v19, v58, v59
    v_fmac_f32 v16, v62, v60
    v_fmac_f32 v17, v62, v61
    v_fmac_f32 v19, v62, v63
    v_min_u32 v16, -2, v16
    v_min_u32 v17, -2, v17
    v_min_u32 v18, -2, v18
    v_min_u32 v19, -2, v19
    global_store_dwordx4 v6, v[16:19], s[26:27] sc1
L_poll2:
    global_load_dwordx4 v[72:75], v8, s[26:27] offset:-4096 sc1
    global_load_dwordx4 v[76:79], v8, s[26:27] offset:-3072 sc1
    global_load_dwordx4 v[80:83], v8, s[26:27] offset:-2048 sc1
    global_load_dwordx4 v[84:87], v8, s[26:27] offset:-1024 sc1
    global_load_dwordx4 v[88:91], v8, s[26:27] offset:0 sc1
    global_load_dwordx4 v[92:95], v8, s[26:27] offset:1024 sc1
    global_load_dwordx4 v[96:99], v8, s[26:27] offset:2048 sc1
    global_load_dwordx4 v[100:103], v8, s[26:27] offset:3072 sc1
    s_sub_u32 s36, s36, 1
    s_cmp_eq_u32 s36, 0
    s_cbranch_scc1 L_svc_end
    s_waitcnt vmcnt(0)
    v_max3_u32 v12, v72, v73, v74
    v_max3_u32 v12, v12, v75, v76
    v_max3_u32 v12, v12, v77, v78
    v_max3_u32 v12, v12, v79, v80
    v_max3_u32 v12, v12, v81, v82
    v_max3_u32 v12, v12, v83, v84
    v_max3_u32 v12, v12, v85, v86
    v_max3_u32 v12, v12, v87, v88
    v_max3_u32 v12, v12, v89, v90
    v_max3_u32 v12, v12, v91, v92
    v_max3_u32 v12, v12, v93, v94
    v_max3_u32 v12, v12, v95, v96
    v_max3_u32 v12, v12, v97, v98
    v_max3_u32 v12, v12, v99, v100
    v_max3_u32 v12, v12, v101, v102
    v_max_u32 v12, v12, v103
    v_cmp_eq_u32 vcc, -1, v12
    s_cbranch_vccz L_got2
    s_sleep 2
    s_branch L_poll2
L_got2:
    v_max3_f32 v18, v74, v78, v82
    v_max3_f32 v12, v86, v90, v94
    v_max3_f32 v18, v18, v98, v102
    v_max_f32 v18, v18, v12
    v_sub_f32 v34, v74, v18
    v_sub_f32 v38, v78, v18
    v_sub_f32 v42, v82, v18
    v_sub_f32 v46, v86, v18
    v_sub_f32 v50, v90, v18
    v_sub_f32 v54, v94, v18
    v_sub_f32 v58, v98, v18
    v_sub_f32 v62, v102, v18
    v_mul_f32 v34, 0x3fb8aa3b, v34
    v_mul_f32 v38, 0x3fb8aa3b, v38
    v_mul_f32 v42, 0x3fb8aa3b, v42
    v_mul_f32 v46, 0x3fb8aa3b, v46
    v_mul_f32 v50, 0x3fb8aa3b, v50
    v_mul_f32 v54, 0x3fb8aa3b, v54
    v_mul_f32 v58, 0x3fb8aa3b, v58
    v_mul_f32 v62, 0x3fb8aa3b, v62
    v_exp_f32 v34, v34
    v_exp_f32 v38, v38
    v_exp_f32 v42, v42
    v_exp_f32 v46, v46
    v_exp_f32 v50, v50
    v_exp_f32 v54, v54
    v_exp_f32 v58, v58
    v_exp_f32 v62, v62
    v_mul_f32 v16, v34, v72
    v_mul_f32 v17, v34, v73
    v_mul_f32 v19, v34, v75
    v_fmac_f32 v16, v38, v76
    v_fmac_f32 v17, v38, v77
    v_fmac_f32 v19, v38, v79
    v_fmac_f32 v16, v42, v80
    v_fmac_f32 v17, v42, v81
    v_fmac_f32 v19, v42, v83
    v_fmac_f32 v16, v46, v84
    v_fmac_f32 v17, v46, v85
    v_fmac_f32 v19, v46, v87
    v_fmac_f32 v16, v50, v88
    v_fmac_f32 v17, v50, v89
    v_fmac_f32 v19, v50, v91
    v_fmac_f32 v16, v54, v92
    v_fmac_f32 v17, v54, v93
    v_fmac_f32 v19, v54, v95
    v_fmac_f32 v16, v58, v96
    v_fmac_f32 v17, v58, v97
    v_fmac_f32 v19, v58, v99
    v_fmac_f32 v16, v62, v100
    v_fmac_f32 v17, v62, v101
    v_fmac_f32 v19, v62, v103
    v_rcp_f32 v12, v19
    s_nop 0
    v_mul_f32 v14, v16, v12
    v_mul_f32 v15, v17, v12
    v_cvt_pk_bf16_f32 v14, v14, v14
    v_cvt_pk_bf16_f32 v15, v15, v15
    ds_write_b64 v5, v[14:15] offset:13056
    s_waitcnt lgkmcnt(0)
    s_barrier
    s_cmp_lt_u32 s3, 28
    s_cselect_b32 s32, -1, 0
    s_barrier
    ds_read_b128 v[32:35], v4 offset:0
    ds_read_b128 v[36:39], v4 offset:1536
    ds_read_b128 v[40:43], v4 offset:3072
    ds_read_b128 v[44:47], v4 offset:4608
    ds_read_b128 v[48:51], v4 offset:6144
    ds_read_b128 v[52:55], v4 offset:7680
    ds_read_b128 v[56:59], v4 offset:9216
    ds_read_b128 v[60:63], v4 offset:10752
    s_waitcnt lgkmcnt(6)
    v_add_f32 v16, v32, v36
    v_add_f32 v17, v33, v37
    v_add_f32 v18, v34, v38
    v_add_f32 v19, v35, v39
    s_waitcnt lgkmcnt(5)
    v_add_f32 v16, v16, v40
    v_add_f32 v17, v17, v41
    v_add_f32 v18, v18, v42
    v_add_f32 v19, v19, v43
    s_waitcnt lgkmcnt(4)
    v_add_f32 v16, v16, v44
    v_add_f32 v17, v17, v45
    v_add_f32 v18, v18, v46
    v_add_f32 v19, v19, v47
    s_waitcnt lgkmcnt(3)
    v_add_f32 v16, v16, v48
    v_add_f32 v17, v17, v49
    v_add_f32 v18, v18, v50
    v_add_f32 v19, v19, v51
    s_waitcnt lgkmcnt(2)
    v_add_f32 v16, v16, v52
    v_add_f32 v17, v17, v53
    v_add_f32 v18, v18, v54
    v_add_f32 v19, v19, v55
    s_waitcnt lgkmcnt(1)
    v_add_f32 v16, v16, v56
    v_add_f32 v17, v17, v57
    v_add_f32 v18, v18, v58
    v_add_f32 v19, v19, v59
    s_waitcnt lgkmcnt(0)
    v_add_f32 v16, v16, v60
    v_add_f32 v17, v17, v61
    v_add_f32 v18, v18, v62
    v_add_f32 v19, v19, v63
    v_min_u32 v16, -2, v16
    v_min_u32 v17, -2, v17
    v_min_u32 v18, -2, v18
    v_min_u32 v19, -2, v19
    s_mov_b32 exec_hi, s32
    global_store_dwordx4 v7, v[16:19], s[26:27] sc1
    s_mov_b64 exec, -1
    s_cmp_ge_u32 s29, 4
    s_cbranch_scc1 L_svc_end
L_poll3:
    global_load_dwordx4 v[124:127], v10, s[26:27] sc1
    global_load_dwordx4 v[128:131], v65, s[26:27] sc1
    global_load_dwordx4 v[132:135], v66, s[26:27] sc1
    global_load_dwordx4 v[136:139], v67, s[26:27] sc1
    global_load_dwordx4 v[140:143], v68, s[26:27] sc1
    global_load_dwordx4 v[144:147], v69, s[26:27] sc1
    global_load_dwordx4 v[148:151], v70, s[26:27] sc1
    global_load_dwordx4 v[152:155], v71, s[26:27] sc1
    s_sub_u32 s36, s36, 1
    s_cmp_eq_u32 s36, 0
    s_cbranch_scc1 L_svc_end
    s_waitcnt vmcnt(0)
    v_max3_u32 v12, v124, v125, v126
    v_max3_u32 v12, v12, v127, v128
    v_max3_u32 v12, v12, v129, v130
    v_max3_u32 v12, v12, v131, v132
    v_max3_u32 v12, v12, v133, v134
    v_max3_u32 v12, v12, v135, v136
    v_max3_u32 v12, v12, v137, v138
    v_max3_u32 v12, v12, v139, v140
    v_max3_u32 v12, v12, v141, v142
    v_max3_u32 v12, v12, v143, v144
    v_max3_u32 v12, v12, v145, v146
    v_max3_u32 v12, v12, v147, v148
    v_max3_u32 v12, v12, v149, v150
    v_max3_u32 v12, v12, v151, v152
    v_max3_u32 v12, v12, v153, v154
    v_max_u32 v12, v12, v155
    v_cmp_eq_u32 vcc, -1, v12
    s_cbranch_vccz L_got3
    s_sleep 2
    s_branch L_poll3
L_got3:
    v_add_f32 v32, v124, v128
    v_add_f32 v40, v132, v136
    v_add_f32 v33, v125, v129
    v_add_f32 v41, v133, v137
    v_add_f32 v34, v126, v130
    v_add_f32 v42, v134, v138
    v_add_f32 v35, v127, v131
    v_add_f32 v43, v135, v139
    v_add_f32 v48, v140, v144
    v_add_f32 v56, v148, v152
    v_add_f32 v49, v141, v145
    v_add_f32 v57, v149, v153
    v_add_f32 v50, v142, v146
    v_add_f32 v58, v150, v154
    v_add_f32 v51, v143, v147
    v_add_f32 v59, v151, v155
    v_add_f32 v32, v32, v40
    v_add_f32 v33, v33, v41
    v_add_f32 v34, v34, v42
    v_add_f32 v35, v35, v43
    v_add_f32 v48, v48, v56
    v_add_f32 v49, v49, v57
    v_add_f32 v50, v50, v58
    v_add_f32 v51, v51, v59
    v_permlane32_swap_b32 v32, v48
    v_permlane32_swap_b32 v33, v49
    v_permlane32_swap_b32 v34, v50
    v_permlane32_swap_b32 v35, v51
    v_add_f32 v32, v32, v48
    v_add_f32 v33, v33, v49
    v_add_f32 v34, v34, v50
    v_add_f32 v35, v35, v51
    v_permlane16_swap_b32 v32, v33
    s_nop 0
    v_permlane16_swap_b32 v34, v35
    v_add_f32 v12, v32, v33
    v_add_f32 v13, v34, v35
    s_nop 0
    v_add_f32_dpp v12, v12, v12 row_ror:8 row_mask:0xf bank_mask:0xf
    v_add_f32_dpp v13, v13, v13 row_ror:8 row_mask:0xf bank_mask:0xf
    v_cvt_pk_bf16_f32 v12, v12, v12
    v_lshlrev_b32 v12, 16, v12
    v_cvt_pk_bf16_f32 v13, v13, v13
    v_lshlrev_b32 v13, 16, v13
    v_permlane32_swap_b32 v12, v14
    s_nop 0
    v_permlane32_swap_b32 v13, v15
    v_lshlrev_b32 v24, 16, v24
    v_lshlrev_b32 v25, 16, v25
    v_add_f32 v12, v12, v24
    v_add_f32 v13, v13, v25
    v_cvt_pk_bf16_f32 v12, v12, v12
    v_lshlrev_b32 v12, 16, v12
    v_cvt_pk_bf16_f32 v13, v13, v13
    v_lshlrev_b32 v13, 16, v13
    v_add_f32 v12, v12, v14
    v_add_f32 v13, v13, v15
    v_cvt_pk_bf16_f32 v12, v12, v12
    v_cvt_pk_bf16_f32 v13, v13, v13
    s_mov_b64 exec, 0x00ff00ff
    global_store_short v9, v12, s[22:23]
    global_store_short v9, v13, s[22:23] offset:4
    s_cmp_lg_u32 s2, 0
    s_cbranch_scc1 L_noepoch
    s_mov_b64 exec, 1
    v_mov_b32 v14, 0x1fff00
    v_mov_b32 v15, s40
    global_store_dword v14, v15, s[26:27] sc1
    v_mov_b32 v12, 0x240000
    v_mov_b32 v13, s41
    global_store_dword v12, v13, s[26:27] sc1
L_noepoch:
L_svc_end:
L_end:
    s_endpgm
.section .rodata,"a"
.p2align 6
.amdhsa_kernel parallel_sum__mha_block_cached__geglu_ffn__decode_kernel
  .amdhsa_next_free_vgpr 166
  .amdhsa_next_free_sgpr 63
  .amdhsa_accum_offset 168
  .amdhsa_group_segment_fixed_size 0
  .amdhsa_kernarg_size 96
  .amdhsa_user_sgpr_count 2
  .amdhsa_user_sgpr_kernarg_segment_ptr 1
  .amdhsa_system_sgpr_workgroup_id_x 1
  .amdhsa_float_denorm_mode_32 3
  .amdhsa_float_denorm_mode_16_64 3
.end_amdhsa_kernel
```
